```python
import torch

def _softmax(x, axis=-1):
    return torch.softmax(x, dim=axis)
def _gelu(x):
    return torch.nn.functional.gelu(x, approximate="tanh")
def _silu(x):
    return torch.nn.functional.silu(x)
def _sigmoid(x):
    return torch.sigmoid(x)
def _layernorm(x, axis=-1, eps=1e-5):
    m = x.mean(dim=axis, keepdim=True)
    v = x.var(dim=axis, keepdim=True, unbiased=False)
    return (x - m) / torch.sqrt(v + eps)
def _scatter_add(tgt, idx, src, axis=0):
    return tgt.clone().index_add_(axis, idx, src)
def _segment_sum(src, seg, n):
    out = torch.zeros((n,) + src.shape[1:], dtype=src.dtype)
    return out.index_add_(0, seg, src)
def _pad(x, pw):
    flat = tuple(v for pair in reversed(pw) for v in pair)
    return torch.nn.functional.pad(x, flat)

kernel_name = 'interleave_layers__sliding_block_cached__mixer_token_mlp__decode'

def setup_inputs():

    _w = (lambda a: (lambda t: t.to(torch.bfloat16) if t.is_floating_point() else t)(torch.as_tensor(a)))
    def _A_setup():
        B, Sq, D = 4, 1, 512
        Hq, Hkv, Sk, Dh = 32, 8, 16384, 128
        assert Hq % Hkv == 0, (Hq, Hkv)
        return {
            "x": _w((lambda *s: torch.randn(*s, dtype=torch.bfloat16) * 0.05)(B, Sq, D)),
            "k_cache": _w((lambda *s: torch.randn(*s, dtype=torch.bfloat16) * 0.8)(B, Hkv, Sk, Dh)),
            "v_cache": _w((lambda *s: torch.randn(*s, dtype=torch.bfloat16) * 1.6)(B, Hkv, Sk, Dh)),
            "wq": _w((lambda *s: torch.randn(*s, dtype=torch.bfloat16) * 0.8)(D, Hq * Dh) * (D ** -0.5)),
            "wo": _w((lambda *s: torch.randn(*s, dtype=torch.bfloat16) * 1.6)(Hq * Dh, D) * ((Hq * Dh) ** -0.5)),
        }
    _A_in = _A_setup()

    def _B_setup():
        B, S, D, F = 4, 1, 512, 1792
        return {
            "x": _w((lambda *s: torch.randn(*s, dtype=torch.bfloat16) * 0.05)(B, S, D)),
            "w1": _w((lambda *s: torch.randn(*s, dtype=torch.bfloat16) * 0.8)(S, F) * (S ** -0.5)),
            "b1": _w((lambda *s: torch.randn(*s, dtype=torch.bfloat16) * 0.2)(F) * 0.02),
            "w2": _w((lambda *s: torch.randn(*s, dtype=torch.bfloat16) * 0.2)(F, S) * (F ** -0.5)),
            "b2": _w((lambda *s: torch.randn(*s, dtype=torch.bfloat16) * 0.2)(S) * 0.02),
        }
    _B_in = _B_setup()

    return {
        "A_x": _A_in["x"],
        "A_k_cache": _A_in["k_cache"],
        "A_v_cache": _A_in["v_cache"],
        "A_wq": _A_in["wq"],
        "A_wo": _A_in["wo"],
        "B_x": _B_in["x"],
        "B_w1": _B_in["w1"],
        "B_b1": _B_in["b1"],
        "B_w2": _B_in["w2"],
        "B_b2": _B_in["b2"],
    }

def reference(A_x, A_k_cache, A_v_cache, A_wq, A_wo, B_x, B_w1, B_b1, B_w2, B_b2):
    def _A_ref(x, k_cache, v_cache, wq, wo):
        B, Sq, D = x.shape
        Hq, Dh = 32, 128
        Hkv, Sk = k_cache.shape[1], k_cache.shape[2]
        W = min(4096, max(256, Sk // 4))
        rep = Hq // Hkv
        q = (lambda x, *d: x.permute(*d))((x @ wq).reshape(B, Sq, Hq, Dh), 0, 2, 1, 3)
        k = (lambda x, n, axis: torch.repeat_interleave(x, n, dim=axis))(k_cache[:, :, Sk - W:, :], rep, axis=1)
        v = (lambda x, n, axis: torch.repeat_interleave(x, n, dim=axis))(v_cache[:, :, Sk - W:, :], rep, axis=1)
        scores = torch.einsum("bhqd,bhkd->bhqk", q, k) * (Dh ** -0.5)
        p = _softmax(scores, axis=-1)
        o = torch.einsum("bhqk,bhkd->bhqd", p, v)
        return (lambda x, *d: x.permute(*d))(o, 0, 2, 1, 3).reshape(B, Sq, Hq * Dh) @ wo

    def _B_ref(x, w1, b1, w2, b2):
        B, S, D = x.shape
        h = _layernorm(x, axis=-1)
        u = torch.einsum("bsd,sf->bdf", h, w1) + b1
        u = _gelu(u)
        y = torch.einsum("bdf,fs->bds", u, w2) + b2
        return (lambda x, *d: x.permute(*d))(y, 0, 2, 1)

    x = A_x
    x = x + _A_ref(_layernorm(x, axis=-1), A_k_cache, A_v_cache, A_wq, A_wo)
    x = x + _B_ref(_layernorm(x, axis=-1), B_w1, B_b1, B_w2, B_b2)
    x = x + _A_ref(_layernorm(x, axis=-1), A_k_cache, A_v_cache, A_wq, A_wo)
    x = x + _B_ref(_layernorm(x, axis=-1), B_w1, B_b1, B_w2, B_b2)
    return x
```

```asm
; @launch grid=(256,1,1) block=(512,1,1) lds=163840
.amdgcn_target "amdgcn-amd-amdhsa--gfx950"
.text
.globl interleave_layers__sliding_block_cached__mixer_token_mlp__decode_kernel
.p2align 8
.type interleave_layers__sliding_block_cached__mixer_token_mlp__decode_kernel,@function
interleave_layers__sliding_block_cached__mixer_token_mlp__decode_kernel:
L_start:
    s_cmp_ge_u32 s2, 256
    s_cbranch_scc1 L_end
    s_load_dwordx16 s[4:19], s[0:1], 0
    s_load_dwordx8 s[20:27], s[0:1], 64
    s_load_dwordx2 s[28:29], s[0:1], 96
    v_lshrrev_b32 v1, 6, v0
    v_and_b32 v0, 63, v0
    s_and_b32 s53, s2, 7
    v_readfirstlane_b32 s3, v1
    s_bfe_u32 s54, s2, 0x30003
    s_lshr_b32 s52, s2, 6
    s_lshl3_add_u32 s56, s52, s53
    s_lshl3_add_u32 s55, s56, s54
    s_lshl_b32 s30, s56, 22
    s_lshl_b32 s31, s54, 17
    s_add_u32 s30, s30, s31
    s_add_u32 s30, s30, 0x300000
    v_lshlrev_b32 v1, 4, v0
    v_lshrrev_b32 v2, 4, v0
    v_and_b32 v3, 15, v0
    s_lshl_b32 s80, s3, 14
    s_add_u32 s81, s80, 0x1000
    s_add_u32 s82, s80, 0x2000
    s_add_u32 s83, s80, 0x3000
    s_mov_b32 s57, 0
    s_mov_b32 s34, 0x20000
    s_mov_b32 s35, 0x20000
    s_mov_b32 s38, 0x20000
    s_mov_b32 s39, 0x20000
    s_mov_b32 s42, 0x400000
    s_mov_b32 s43, 0x20000
    s_mov_b32 s46, 0x400000
    s_mov_b32 s47, 0x20000
    s_mov_b32 s50, 1822720
    s_mov_b32 s51, 0x20000
    s_waitcnt lgkmcnt(0)
    s_add_u32 s32, s6, s30
    s_addc_u32 s33, s7, 0
    s_add_u32 s36, s8, s30
    s_addc_u32 s37, s9, 0
    s_mov_b32 s40, s10
    s_mov_b32 s41, s11
    s_mov_b32 s44, s12
    s_mov_b32 s45, s13
    s_mov_b32 s48, s28
    s_mov_b32 s49, s29
    s_add_u32 s80, s3, s2
    s_lshl3_add_u32 s81, s54, s80
    s_mul_i32 s81, s81, 5
    s_and_b32 s81, s81, 15
    s_add_u32 s80, s80, s54
    s_add_u32 s80, s80, s52
    s_and_b32 s80, s80, 7
    s_lshl4_add_u32 s80, s80, s81
    s_lshl_b32 s80, s80, 10
    s_cmp_lg_u32 s3, 0
    s_cbranch_scc1 L_w17
    v_lshrrev_b32 v4, 2, v3
    v_add_u32 v4, s52, v4
    v_and_b32 v4, 3, v4
    v_lshlrev_b32 v4, 8, v4
    v_and_b32 v5, 3, v3
    v_lshl_add_u32 v4, v5, 10, v4
    v_lshl_add_u32 v4, v2, 4, v4
    global_load_dwordx4 v[16:19], v4, s[4:5] offset:0
    global_load_dwordx4 v[20:23], v4, s[4:5] offset:64
    global_load_dwordx4 v[24:27], v4, s[4:5] offset:128
    global_load_dwordx4 v[28:31], v4, s[4:5] offset:192
    s_lshl_b32 s30, s52, 20
    s_lshl_b32 s31, s53, 10
    s_add_u32 s30, s30, s31
    s_lshl_b32 s31, s54, 7
    s_add_u32 s30, s30, s31
    s_mov_b32 s31, 139264
    v_lshrrev_b32 v6, 3, v0
    v_lshlrev_b32 v6, 13, v6
    v_bfe_u32 v7, v0, 4, 1
    v_lshlrev_b32 v7, 1, v7
    v_and_b32 v8, 7, v0
    v_xor_b32 v7, v7, v8
    v_lshl_add_u32 v6, v7, 4, v6
    v_xor_b32 v7, 64, v6
    s_mov_b32 m0, s31
    s_add_u32 s31, s31, 1024
    buffer_load_dwordx4 v6, s[40:43], s30 offen lds
    s_add_u32 s30, s30, 65536
    s_mov_b32 m0, s31
    s_add_u32 s31, s31, 1024
    buffer_load_dwordx4 v7, s[40:43], s30 offen lds
    s_add_u32 s30, s30, 65536
    s_mov_b32 m0, s31
    s_add_u32 s31, s31, 1024
    buffer_load_dwordx4 v6, s[40:43], s30 offen lds
    s_add_u32 s30, s30, 65536
    s_mov_b32 m0, s31
    s_add_u32 s31, s31, 1024
    buffer_load_dwordx4 v7, s[40:43], s30 offen lds
    s_add_u32 s30, s30, 65536
    s_mov_b32 m0, s31
    s_add_u32 s31, s31, 1024
    buffer_load_dwordx4 v6, s[40:43], s30 offen lds
    s_add_u32 s30, s30, 65536
    s_mov_b32 m0, s31
    s_add_u32 s31, s31, 1024
    buffer_load_dwordx4 v7, s[40:43], s30 offen lds
    s_add_u32 s30, s30, 65536
    s_mov_b32 m0, s31
    s_add_u32 s31, s31, 1024
    buffer_load_dwordx4 v6, s[40:43], s30 offen lds
    s_add_u32 s30, s30, 65536
    s_mov_b32 m0, s31
    s_add_u32 s31, s31, 1024
    buffer_load_dwordx4 v7, s[40:43], s30 offen lds
    s_add_u32 s30, s30, 65536
    s_mov_b32 m0, s31
    s_add_u32 s31, s31, 1024
    buffer_load_dwordx4 v6, s[40:43], s30 offen lds
    s_add_u32 s30, s30, 65536
    s_mov_b32 m0, s31
    s_add_u32 s31, s31, 1024
    buffer_load_dwordx4 v7, s[40:43], s30 offen lds
    s_add_u32 s30, s30, 65536
    s_mov_b32 m0, s31
    s_add_u32 s31, s31, 1024
    buffer_load_dwordx4 v6, s[40:43], s30 offen lds
    s_add_u32 s30, s30, 65536
    s_mov_b32 m0, s31
    s_add_u32 s31, s31, 1024
    buffer_load_dwordx4 v7, s[40:43], s30 offen lds
    s_add_u32 s30, s30, 65536
    s_mov_b32 m0, s31
    s_add_u32 s31, s31, 1024
    buffer_load_dwordx4 v6, s[40:43], s30 offen lds
    s_add_u32 s30, s30, 65536
    s_mov_b32 m0, s31
    s_add_u32 s31, s31, 1024
    buffer_load_dwordx4 v7, s[40:43], s30 offen lds
    s_add_u32 s30, s30, 65536
    s_mov_b32 m0, s31
    s_add_u32 s31, s31, 1024
    buffer_load_dwordx4 v6, s[40:43], s30 offen lds
    s_add_u32 s30, s30, 65536
    s_mov_b32 m0, s31
    s_add_u32 s31, s31, 1024
    buffer_load_dwordx4 v7, s[40:43], s30 offen lds
    s_add_u32 s30, s30, 65536
    v_mov_b32 v6, 163584
    v_mov_b32 v8, 0
    v_mov_b32 v9, 0
    v_mov_b32 v10, 0
    v_mov_b32 v11, 0
    ds_write_b128 v6, v[8:11]
    ds_write_b128 v6, v[8:11] offset:16
    v_and_b32 v13, 31, v0
    v_lshlrev_b32 v13, 10, v13
    s_lshl_b32 s30, s53, 7
    s_add_u32 s30, s30, 1781760
    buffer_load_dword v12, v13, s[48:51], s30 offen
    v_mov_b32 v32, -1
    v_mov_b32 v33, -1
    v_mov_b32 v34, -1
    v_mov_b32 v35, -1
    v_lshlrev_b32 v7, 4, v3
    v_lshl_add_u32 v7, v2, 16, v7
    s_lshl2_add_u32 s30, s53, s52
    s_lshl3_add_u32 s30, s30, s54
    s_lshl_b32 s30, s30, 8
    buffer_store_dwordx4 v[32:35], v7, s[48:51], s30 offen
    s_waitcnt lgkmcnt(0)
    s_barrier
    s_mov_b32 s31, 1515520
    s_load_dwordx2 s[100:101], s[28:29], s31
    s_waitcnt lgkmcnt(0)
    s_andn2_b32 s100, s100, 15
    s_add_u32 s100, s100, 16
    s_addc_u32 s101, s101, 0
    s_getreg_b32 s30, hwreg(HW_REG_XCC_ID,0,4)
    s_or_b32 s100, s100, s30
    s_waitcnt vmcnt(18)
    v_lshlrev_b32 v64, 16, v16
    v_and_b32 v65, 0xffff0000, v16
    v_lshlrev_b32 v66, 16, v17
    v_and_b32 v67, 0xffff0000, v17
    v_lshlrev_b32 v68, 16, v18
    v_and_b32 v69, 0xffff0000, v18
    v_lshlrev_b32 v70, 16, v19
    v_and_b32 v71, 0xffff0000, v19
    v_lshlrev_b32 v72, 16, v20
    v_and_b32 v73, 0xffff0000, v20
    v_lshlrev_b32 v74, 16, v21
    v_and_b32 v75, 0xffff0000, v21
    v_lshlrev_b32 v76, 16, v22
    v_and_b32 v77, 0xffff0000, v22
    v_lshlrev_b32 v78, 16, v23
    v_and_b32 v79, 0xffff0000, v23
    v_lshlrev_b32 v80, 16, v24
    v_and_b32 v81, 0xffff0000, v24
    v_lshlrev_b32 v82, 16, v25
    v_and_b32 v83, 0xffff0000, v25
    v_lshlrev_b32 v84, 16, v26
    v_and_b32 v85, 0xffff0000, v26
    v_lshlrev_b32 v86, 16, v27
    v_and_b32 v87, 0xffff0000, v27
    v_lshlrev_b32 v88, 16, v28
    v_and_b32 v89, 0xffff0000, v28
    v_lshlrev_b32 v90, 16, v29
    v_and_b32 v91, 0xffff0000, v29
    v_lshlrev_b32 v92, 16, v30
    v_and_b32 v93, 0xffff0000, v30
    v_lshlrev_b32 v94, 16, v31
    v_and_b32 v95, 0xffff0000, v31
    v_pk_add_f32 v[36:37], v[64:65], v[66:67]
    v_pk_add_f32 v[36:37], v[36:37], v[68:69]
    v_pk_add_f32 v[36:37], v[36:37], v[70:71]
    v_pk_add_f32 v[36:37], v[36:37], v[72:73]
    v_pk_add_f32 v[36:37], v[36:37], v[74:75]
    v_pk_add_f32 v[36:37], v[36:37], v[76:77]
    v_pk_add_f32 v[36:37], v[36:37], v[78:79]
    v_pk_add_f32 v[36:37], v[36:37], v[80:81]
    v_pk_add_f32 v[36:37], v[36:37], v[82:83]
    v_pk_add_f32 v[36:37], v[36:37], v[84:85]
    v_pk_add_f32 v[36:37], v[36:37], v[86:87]
    v_pk_add_f32 v[36:37], v[36:37], v[88:89]
    v_pk_add_f32 v[36:37], v[36:37], v[90:91]
    v_pk_add_f32 v[36:37], v[36:37], v[92:93]
    v_pk_add_f32 v[36:37], v[36:37], v[94:95]
    v_add_f32 v36, v36, v37
    s_nop 1
    v_add_f32_dpp v36, v36, v36 row_ror:4 row_mask:0xf bank_mask:0xf
    s_nop 1
    v_add_f32_dpp v36, v36, v36 row_ror:8 row_mask:0xf bank_mask:0xf
    v_mov_b32 v37, v36
    s_nop 1
    v_permlane16_swap_b32 v36, v37
    v_add_f32 v36, v36, v37
    v_mov_b32 v37, v36
    s_nop 1
    v_permlane32_swap_b32 v36, v37
    v_add_f32 v36, v36, v37
    v_mul_f32 v36, 0xbb000000, v36
    v_pk_add_f32 v[64:65], v[64:65], v[36:37] op_sel_hi:[1,0]
    v_pk_add_f32 v[66:67], v[66:67], v[36:37] op_sel_hi:[1,0]
    v_pk_add_f32 v[68:69], v[68:69], v[36:37] op_sel_hi:[1,0]
    v_pk_add_f32 v[70:71], v[70:71], v[36:37] op_sel_hi:[1,0]
    v_pk_add_f32 v[72:73], v[72:73], v[36:37] op_sel_hi:[1,0]
    v_pk_add_f32 v[74:75], v[74:75], v[36:37] op_sel_hi:[1,0]
    v_pk_add_f32 v[76:77], v[76:77], v[36:37] op_sel_hi:[1,0]
    v_pk_add_f32 v[78:79], v[78:79], v[36:37] op_sel_hi:[1,0]
    v_pk_add_f32 v[80:81], v[80:81], v[36:37] op_sel_hi:[1,0]
    v_pk_add_f32 v[82:83], v[82:83], v[36:37] op_sel_hi:[1,0]
    v_pk_add_f32 v[84:85], v[84:85], v[36:37] op_sel_hi:[1,0]
    v_pk_add_f32 v[86:87], v[86:87], v[36:37] op_sel_hi:[1,0]
    v_pk_add_f32 v[88:89], v[88:89], v[36:37] op_sel_hi:[1,0]
    v_pk_add_f32 v[90:91], v[90:91], v[36:37] op_sel_hi:[1,0]
    v_pk_add_f32 v[92:93], v[92:93], v[36:37] op_sel_hi:[1,0]
    v_pk_add_f32 v[94:95], v[94:95], v[36:37] op_sel_hi:[1,0]
    v_pk_mul_f32 v[36:37], v[64:65], v[64:65]
    v_pk_fma_f32 v[36:37], v[66:67], v[66:67], v[36:37]
    v_pk_fma_f32 v[36:37], v[68:69], v[68:69], v[36:37]
    v_pk_fma_f32 v[36:37], v[70:71], v[70:71], v[36:37]
    v_pk_fma_f32 v[36:37], v[72:73], v[72:73], v[36:37]
    v_pk_fma_f32 v[36:37], v[74:75], v[74:75], v[36:37]
    v_pk_fma_f32 v[36:37], v[76:77], v[76:77], v[36:37]
    v_pk_fma_f32 v[36:37], v[78:79], v[78:79], v[36:37]
    v_pk_fma_f32 v[36:37], v[80:81], v[80:81], v[36:37]
    v_pk_fma_f32 v[36:37], v[82:83], v[82:83], v[36:37]
    v_pk_fma_f32 v[36:37], v[84:85], v[84:85], v[36:37]
    v_pk_fma_f32 v[36:37], v[86:87], v[86:87], v[36:37]
    v_pk_fma_f32 v[36:37], v[88:89], v[88:89], v[36:37]
    v_pk_fma_f32 v[36:37], v[90:91], v[90:91], v[36:37]
    v_pk_fma_f32 v[36:37], v[92:93], v[92:93], v[36:37]
    v_pk_fma_f32 v[36:37], v[94:95], v[94:95], v[36:37]
    v_add_f32 v36, v36, v37
    s_nop 1
    v_add_f32_dpp v36, v36, v36 row_ror:4 row_mask:0xf bank_mask:0xf
    s_nop 1
    v_add_f32_dpp v36, v36, v36 row_ror:8 row_mask:0xf bank_mask:0xf
    v_mov_b32 v37, v36
    s_nop 1
    v_permlane16_swap_b32 v36, v37
    v_add_f32 v36, v36, v37
    v_mov_b32 v37, v36
    s_nop 1
    v_permlane32_swap_b32 v36, v37
    v_add_f32 v36, v36, v37
    v_mov_b32 v37, 0x3727c5ac
    v_fmac_f32 v37, 0x3b000000, v36
    v_rsq_f32 v36, v37
    s_nop 0
    v_pk_mul_f32 v[64:65], v[64:65], v[36:37] op_sel_hi:[1,0]
    v_pk_mul_f32 v[66:67], v[66:67], v[36:37] op_sel_hi:[1,0]
    v_pk_mul_f32 v[68:69], v[68:69], v[36:37] op_sel_hi:[1,0]
    v_pk_mul_f32 v[70:71], v[70:71], v[36:37] op_sel_hi:[1,0]
    v_pk_mul_f32 v[72:73], v[72:73], v[36:37] op_sel_hi:[1,0]
    v_pk_mul_f32 v[74:75], v[74:75], v[36:37] op_sel_hi:[1,0]
    v_pk_mul_f32 v[76:77], v[76:77], v[36:37] op_sel_hi:[1,0]
    v_pk_mul_f32 v[78:79], v[78:79], v[36:37] op_sel_hi:[1,0]
    v_pk_mul_f32 v[80:81], v[80:81], v[36:37] op_sel_hi:[1,0]
    v_pk_mul_f32 v[82:83], v[82:83], v[36:37] op_sel_hi:[1,0]
    v_pk_mul_f32 v[84:85], v[84:85], v[36:37] op_sel_hi:[1,0]
    v_pk_mul_f32 v[86:87], v[86:87], v[36:37] op_sel_hi:[1,0]
    v_pk_mul_f32 v[88:89], v[88:89], v[36:37] op_sel_hi:[1,0]
    v_pk_mul_f32 v[90:91], v[90:91], v[36:37] op_sel_hi:[1,0]
    v_pk_mul_f32 v[92:93], v[92:93], v[36:37] op_sel_hi:[1,0]
    v_pk_mul_f32 v[94:95], v[94:95], v[36:37] op_sel_hi:[1,0]
    v_cvt_pk_bf16_f32 v16, v64, v65
    v_cvt_pk_bf16_f32 v17, v66, v67
    v_cvt_pk_bf16_f32 v18, v68, v69
    v_cvt_pk_bf16_f32 v19, v70, v71
    v_cvt_pk_bf16_f32 v20, v72, v73
    v_cvt_pk_bf16_f32 v21, v74, v75
    v_cvt_pk_bf16_f32 v22, v76, v77
    v_cvt_pk_bf16_f32 v23, v78, v79
    v_cvt_pk_bf16_f32 v24, v80, v81
    v_cvt_pk_bf16_f32 v25, v82, v83
    v_cvt_pk_bf16_f32 v26, v84, v85
    v_cvt_pk_bf16_f32 v27, v86, v87
    v_cvt_pk_bf16_f32 v28, v88, v89
    v_cvt_pk_bf16_f32 v29, v90, v91
    v_cvt_pk_bf16_f32 v30, v92, v93
    v_cvt_pk_bf16_f32 v31, v94, v95
    v_bfe_u32 v6, v0, 3, 2
    v_xor_b32 v6, 0, v6
    v_lshlrev_b32 v6, 5, v6
    v_and_b32 v7, 3, v0
    v_lshl_add_u32 v6, v7, 3, v6
    v_bfe_u32 v7, v0, 2, 2
    v_lshl_add_u32 v6, v7, 7, v6
    v_lshl_add_u32 v6, v2, 10, v6
    v_add_u32 v6, 139264, v6
    s_waitcnt vmcnt(0)
    ds_read_b64_tr_b16 v[64:65], v6 offset:0
    ds_read_b64_tr_b16 v[66:67], v6 offset:512
    ds_read_b64_tr_b16 v[68:69], v6 offset:4096
    ds_read_b64_tr_b16 v[70:71], v6 offset:4608
    ds_read_b64_tr_b16 v[72:73], v6 offset:8192
    ds_read_b64_tr_b16 v[74:75], v6 offset:8704
    ds_read_b64_tr_b16 v[76:77], v6 offset:12288
    ds_read_b64_tr_b16 v[78:79], v6 offset:12800
    v_xor_b32 v7, 32, v6
    ds_read_b64_tr_b16 v[80:81], v7 offset:0
    ds_read_b64_tr_b16 v[82:83], v7 offset:512
    ds_read_b64_tr_b16 v[84:85], v7 offset:4096
    ds_read_b64_tr_b16 v[86:87], v7 offset:4608
    ds_read_b64_tr_b16 v[88:89], v7 offset:8192
    ds_read_b64_tr_b16 v[90:91], v7 offset:8704
    ds_read_b64_tr_b16 v[92:93], v7 offset:12288
    ds_read_b64_tr_b16 v[94:95], v7 offset:12800
    v_xor_b32 v7, 64, v6
    ds_read_b64_tr_b16 v[96:97], v7 offset:0
    ds_read_b64_tr_b16 v[98:99], v7 offset:512
    ds_read_b64_tr_b16 v[100:101], v7 offset:4096
    ds_read_b64_tr_b16 v[102:103], v7 offset:4608
    ds_read_b64_tr_b16 v[104:105], v7 offset:8192
    ds_read_b64_tr_b16 v[106:107], v7 offset:8704
    ds_read_b64_tr_b16 v[108:109], v7 offset:12288
    ds_read_b64_tr_b16 v[110:111], v7 offset:12800
    v_xor_b32 v7, 96, v6
    ds_read_b64_tr_b16 v[112:113], v7 offset:0
    ds_read_b64_tr_b16 v[114:115], v7 offset:512
    ds_read_b64_tr_b16 v[116:117], v7 offset:4096
    ds_read_b64_tr_b16 v[118:119], v7 offset:4608
    ds_read_b64_tr_b16 v[120:121], v7 offset:8192
    ds_read_b64_tr_b16 v[122:123], v7 offset:8704
    ds_read_b64_tr_b16 v[124:125], v7 offset:12288
    ds_read_b64_tr_b16 v[126:127], v7 offset:12800
    s_waitcnt lgkmcnt(0)
    v_mfma_f32_16x16x32_bf16 v[40:43], v[64:67], v[16:19], 0
    v_mfma_f32_16x16x32_bf16 v[44:47], v[80:83], v[16:19], 0
    v_mfma_f32_16x16x32_bf16 v[48:51], v[96:99], v[16:19], 0
    v_mfma_f32_16x16x32_bf16 v[52:55], v[112:115], v[16:19], 0
    v_mfma_f32_16x16x32_bf16 v[40:43], v[68:71], v[20:23], v[40:43]
    v_mfma_f32_16x16x32_bf16 v[44:47], v[84:87], v[20:23], v[44:47]
    v_mfma_f32_16x16x32_bf16 v[48:51], v[100:103], v[20:23], v[48:51]
    v_mfma_f32_16x16x32_bf16 v[52:55], v[116:119], v[20:23], v[52:55]
    v_mfma_f32_16x16x32_bf16 v[40:43], v[72:75], v[24:27], v[40:43]
    v_mfma_f32_16x16x32_bf16 v[44:47], v[88:91], v[24:27], v[44:47]
    v_mfma_f32_16x16x32_bf16 v[48:51], v[104:107], v[24:27], v[48:51]
    v_mfma_f32_16x16x32_bf16 v[52:55], v[120:123], v[24:27], v[52:55]
    v_mfma_f32_16x16x32_bf16 v[40:43], v[76:79], v[28:31], v[40:43]
    v_mfma_f32_16x16x32_bf16 v[44:47], v[92:95], v[28:31], v[44:47]
    v_mfma_f32_16x16x32_bf16 v[48:51], v[108:111], v[28:31], v[48:51]
    v_mfma_f32_16x16x32_bf16 v[52:55], v[124:127], v[28:31], v[52:55]
    v_lshlrev_b32 v6, 16, v3
    v_lshl_add_u32 v6, v2, 4, v6
    s_lshl2_add_u32 s30, s53, s52
    s_lshl_b32 s30, s30, 11
    s_lshl_b32 s31, s54, 8
    s_add_u32 s30, s30, s31
    s_mov_b32 exec_lo, 0x000f000f
    s_mov_b32 exec_hi, 0x000f000f
    v_min_u32 v40, 0xfffffffe, v40
    v_min_u32 v41, 0xfffffffe, v41
    v_min_u32 v42, 0xfffffffe, v42
    v_min_u32 v43, 0xfffffffe, v43
    v_min_u32 v44, 0xfffffffe, v44
    v_min_u32 v45, 0xfffffffe, v45
    v_min_u32 v46, 0xfffffffe, v46
    v_min_u32 v47, 0xfffffffe, v47
    v_min_u32 v48, 0xfffffffe, v48
    v_min_u32 v49, 0xfffffffe, v49
    v_min_u32 v50, 0xfffffffe, v50
    v_min_u32 v51, 0xfffffffe, v51
    v_min_u32 v52, 0xfffffffe, v52
    v_min_u32 v53, 0xfffffffe, v53
    v_min_u32 v54, 0xfffffffe, v54
    v_min_u32 v55, 0xfffffffe, v55
    buffer_store_dwordx4 v[40:43], v6, s[48:51], s30 offen offset:0
    buffer_store_dwordx4 v[44:47], v6, s[48:51], s30 offen offset:64
    buffer_store_dwordx4 v[48:51], v6, s[48:51], s30 offen offset:128
    buffer_store_dwordx4 v[52:55], v6, s[48:51], s30 offen offset:192
    v_add_u32 v7, 160768, v1
    ds_write_b128 v7, v[40:43] offset:0
    ds_write_b128 v7, v[44:47] offset:64
    ds_write_b128 v7, v[48:51] offset:128
    ds_write_b128 v7, v[52:55] offset:192
    s_lshr_b32 s30, s30, 6
    s_add_u32 s30, s30, 1781760
    s_mov_b32 exec_lo, -1
    s_mov_b32 exec_hi, 0
    v_mov_b32 v8, s100
    buffer_store_dword v8, v13, s[48:51], s30 offen
    s_mov_b64 exec, 1
    v_mov_b32 v8, 163584
    v_mov_b32 v9, 1
    ds_add_u32 v8, v9 offset:16
    s_mov_b64 exec, -1
L_poll:
    s_mov_b32 s59, 40
    s_lshl_b32 s30, s53, 7
    s_add_u32 s30, s30, 1781760
    s_add_u32 s60, s30, 64
    s_mov_b32 s61, s101
    s_mov_b32 s101, s100
    s_setprio 3
L_fl0:
    s_load_dwordx16 s[84:99], s[28:29], s30
    s_load_dwordx16 s[4:19], s[28:29], s60
    s_branch L_fl1
L_fl:
    s_load_dwordx16 s[84:99], s[28:29], s30 glc
    s_load_dwordx16 s[4:19], s[28:29], s60 glc
L_fl1:
    s_waitcnt lgkmcnt(0)
    s_xor_b64 s[84:85], s[84:85], s[100:101]
    s_xor_b64 s[86:87], s[86:87], s[100:101]
    s_xor_b64 s[88:89], s[88:89], s[100:101]
    s_xor_b64 s[90:91], s[90:91], s[100:101]
    s_xor_b64 s[92:93], s[92:93], s[100:101]
    s_xor_b64 s[94:95], s[94:95], s[100:101]
    s_xor_b64 s[96:97], s[96:97], s[100:101]
    s_xor_b64 s[98:99], s[98:99], s[100:101]
    s_xor_b64 s[4:5], s[4:5], s[100:101]
    s_xor_b64 s[6:7], s[6:7], s[100:101]
    s_xor_b64 s[8:9], s[8:9], s[100:101]
    s_xor_b64 s[10:11], s[10:11], s[100:101]
    s_xor_b64 s[12:13], s[12:13], s[100:101]
    s_xor_b64 s[14:15], s[14:15], s[100:101]
    s_xor_b64 s[16:17], s[16:17], s[100:101]
    s_xor_b64 s[18:19], s[18:19], s[100:101]
    s_or_b64 s[84:85], s[84:85], s[86:87]
    s_or_b64 s[84:85], s[84:85], s[88:89]
    s_or_b64 s[84:85], s[84:85], s[90:91]
    s_or_b64 s[84:85], s[84:85], s[92:93]
    s_or_b64 s[84:85], s[84:85], s[94:95]
    s_or_b64 s[84:85], s[84:85], s[96:97]
    s_or_b64 s[84:85], s[84:85], s[98:99]
    s_or_b64 s[84:85], s[84:85], s[4:5]
    s_or_b64 s[84:85], s[84:85], s[6:7]
    s_or_b64 s[84:85], s[84:85], s[8:9]
    s_or_b64 s[84:85], s[84:85], s[10:11]
    s_or_b64 s[84:85], s[84:85], s[12:13]
    s_or_b64 s[84:85], s[84:85], s[14:15]
    s_or_b64 s[84:85], s[84:85], s[16:17]
    s_or_b64 s[84:85], s[84:85], s[18:19]
    s_cbranch_scc0 L_flok
    s_mov_b32 s31, 2
L_1:
    s_nop 15
    s_sub_u32 s31, s31, 1
    s_cbranch_scc0 L_1
    s_sub_u32 s59, s59, 1
    s_cbranch_scc1 L_q1slow
    s_cmp_ge_u32 s30, 1813504
    s_cbranch_scc1 L_fl
    s_add_u32 s30, s30, 1024
    s_add_u32 s60, s60, 1024
    s_branch L_fl0
L_flok:
    s_mov_b32 s101, s61
    s_mov_b32 s58, 1
    s_lshl_b32 s30, s56, 13
    s_add_u32 s31, s30, 4096
    buffer_load_dwordx4 v[16:19], v1, s[48:51], s30 offen offset:0 sc1
    buffer_load_dwordx4 v[20:23], v1, s[48:51], s30 offen offset:1024 sc1
    buffer_load_dwordx4 v[24:27], v1, s[48:51], s30 offen offset:2048 sc1
    buffer_load_dwordx4 v[28:31], v1, s[48:51], s30 offen offset:3072 sc1
    buffer_load_dwordx4 v[32:35], v1, s[48:51], s31 offen offset:0 sc1
    buffer_load_dwordx4 v[36:39], v1, s[48:51], s31 offen offset:1024 sc1
    buffer_load_dwordx4 v[40:43], v1, s[48:51], s31 offen offset:2048 sc1
    buffer_load_dwordx4 v[44:47], v1, s[48:51], s31 offen offset:3072 sc1
    s_mov_b32 s59, 262144
    s_waitcnt vmcnt(0)
L_q1chk:
    v_max_u32 v48, v16, v17
    v_max3_u32 v48, v48, v18, v19
    v_max3_u32 v48, v48, v20, v21
    v_max3_u32 v48, v48, v22, v23
    v_max3_u32 v48, v48, v24, v25
    v_max3_u32 v48, v48, v26, v27
    v_max3_u32 v48, v48, v28, v29
    v_max3_u32 v48, v48, v30, v31
    v_max3_u32 v48, v48, v32, v33
    v_max3_u32 v48, v48, v34, v35
    v_max3_u32 v48, v48, v36, v37
    v_max3_u32 v48, v48, v38, v39
    v_max3_u32 v48, v48, v40, v41
    v_max3_u32 v48, v48, v42, v43
    v_max3_u32 v48, v48, v44, v45
    v_max3_u32 v48, v48, v46, v47
    v_cmp_eq_u32 vcc, -1, v48
    s_sub_u32 s59, s59, 1
    s_cbranch_scc1 L_q1ret
    s_cbranch_vccnz L_q1s3
L_q1ret:
    v_pk_add_f32 v[16:17], v[16:17], v[24:25]
    v_pk_add_f32 v[32:33], v[32:33], v[40:41]
    v_pk_add_f32 v[16:17], v[16:17], v[32:33]
    v_pk_add_f32 v[18:19], v[18:19], v[26:27]
    v_pk_add_f32 v[34:35], v[34:35], v[42:43]
    v_pk_add_f32 v[18:19], v[18:19], v[34:35]
    v_pk_add_f32 v[20:21], v[20:21], v[28:29]
    v_pk_add_f32 v[36:37], v[36:37], v[44:45]
    v_pk_add_f32 v[20:21], v[20:21], v[36:37]
    v_pk_add_f32 v[22:23], v[22:23], v[30:31]
    v_pk_add_f32 v[38:39], v[38:39], v[46:47]
    v_pk_add_f32 v[22:23], v[22:23], v[38:39]
    v_cvt_pk_bf16_f32 v16, v16, v17
    v_cvt_pk_bf16_f32 v17, v18, v19
    v_cvt_pk_bf16_f32 v18, v20, v21
    v_cvt_pk_bf16_f32 v19, v22, v23
    v_lshrrev_b32 v20, 5, v0
    v_lshlrev_b32 v20, 6, v20
    v_lshl_add_u32 v20, v0, 3, v20
    v_add_u32 v20, 158464, v20
    ds_write_b64 v20, v[16:17]
    ds_write_b64 v20, v[18:19] offset:640
    s_add_u32 s31, s58, 1
    v_mov_b32 v21, 163584
    v_mov_b32 v22, s31
    ds_write_b32 v21, v22 offset:4
    s_setprio 0
    s_xor_b32 s84, s80, 0
    s_xor_b32 s85, s80, 1024
    s_xor_b32 s86, s80, 2048
    s_xor_b32 s87, s80, 3072
    s_xor_b32 s88, s80, 4096
    s_xor_b32 s89, s80, 5120
    s_xor_b32 s90, s80, 6144
    s_xor_b32 s91, s80, 7168
    s_xor_b32 s92, s80, 8192
    s_xor_b32 s93, s80, 9216
    s_xor_b32 s94, s80, 10240
    s_xor_b32 s95, s80, 11264
    s_xor_b32 s96, s80, 12288
    s_xor_b32 s97, s80, 13312
    s_xor_b32 s98, s80, 14336
    s_xor_b32 s99, s80, 15360
    buffer_load_dwordx4 v[128:131], v1, s[32:35], s84 offen nt
    buffer_load_dwordx4 v[132:135], v1, s[32:35], s85 offen nt
    buffer_load_dwordx4 v[136:139], v1, s[32:35], s86 offen nt
    buffer_load_dwordx4 v[140:143], v1, s[32:35], s87 offen nt
    buffer_load_dwordx4 v[144:147], v1, s[32:35], s88 offen nt
    buffer_load_dwordx4 v[148:151], v1, s[32:35], s89 offen nt
    buffer_load_dwordx4 v[152:155], v1, s[32:35], s90 offen nt
    buffer_load_dwordx4 v[156:159], v1, s[32:35], s91 offen nt
    buffer_load_dwordx4 v[160:163], v1, s[32:35], s92 offen nt
    buffer_load_dwordx4 v[164:167], v1, s[32:35], s93 offen nt
    buffer_load_dwordx4 v[168:171], v1, s[32:35], s94 offen nt
    buffer_load_dwordx4 v[172:175], v1, s[32:35], s95 offen nt
    buffer_load_dwordx4 v[176:179], v1, s[32:35], s96 offen nt
    buffer_load_dwordx4 v[180:183], v1, s[32:35], s97 offen nt
    buffer_load_dwordx4 v[184:187], v1, s[32:35], s98 offen nt
    buffer_load_dwordx4 v[188:191], v1, s[32:35], s99 offen nt
    buffer_load_dwordx4 v[192:195], v1, s[36:39], s84 offen nt
    buffer_load_dwordx4 v[196:199], v1, s[36:39], s85 offen nt
    buffer_load_dwordx4 v[200:203], v1, s[36:39], s86 offen nt
    buffer_load_dwordx4 v[204:207], v1, s[36:39], s87 offen nt
    buffer_load_dwordx4 v[208:211], v1, s[36:39], s88 offen nt
    buffer_load_dwordx4 v[212:215], v1, s[36:39], s89 offen nt
    buffer_load_dwordx4 v[216:219], v1, s[36:39], s90 offen nt
    buffer_load_dwordx4 v[220:223], v1, s[36:39], s91 offen nt
    buffer_load_dwordx4 v[224:227], v1, s[36:39], s92 offen nt
    buffer_load_dwordx4 v[228:231], v1, s[36:39], s93 offen nt
    buffer_load_dwordx4 v[232:235], v1, s[36:39], s94 offen nt
    buffer_load_dwordx4 v[236:239], v1, s[36:39], s95 offen nt
    buffer_load_dwordx4 v[240:243], v1, s[36:39], s96 offen nt
    buffer_load_dwordx4 v[244:247], v1, s[36:39], s97 offen nt
    buffer_load_dwordx4 v[248:251], v1, s[36:39], s98 offen nt
    buffer_load_dwordx4 v[252:255], v1, s[36:39], s99 offen nt
    s_branch L_B1
L_w17:
    s_cmp_lg_u32 s3, 3
    s_cbranch_scc1 L_ncl
    v_mov_b32 v32, -1
    v_mov_b32 v33, -1
    v_mov_b32 v34, -1
    v_mov_b32 v35, -1
    s_lshl_b32 s30, s55, 11
    s_add_u32 s30, s30, 262144
    s_add_u32 s31, s30, 0x80000
    buffer_store_dwordx4 v[32:35], v1, s[48:51], s30 offen sc1
    buffer_store_dwordx4 v[32:35], v1, s[48:51], s30 offen offset:1024 sc1
    buffer_store_dwordx4 v[32:35], v1, s[48:51], s31 offen sc1
    buffer_store_dwordx4 v[32:35], v1, s[48:51], s31 offen offset:1024 sc1
    v_lshlrev_b32 v6, 4, v3
    v_lshl_add_u32 v6, v2, 16, v6
    s_lshl2_add_u32 s30, s53, s52
    s_lshl3_add_u32 s30, s30, s54
    s_lshl_b32 s30, s30, 8
    s_add_u32 s30, s30, 1519616
    buffer_store_dwordx4 v[32:35], v6, s[48:51], s30 offen sc1
    s_lshl_b32 s30, s55, 8
    s_add_u32 s30, s30, 1327104
    s_mov_b32 exec_hi, 0
    buffer_store_dwordx4 v[32:35], v6, s[48:51], s30 offen sc1
    s_lshl_b32 s30, s55, 7
    s_add_u32 s30, s30, 1458176
    s_mov_b64 exec, 0xff
    buffer_store_dwordx4 v[32:35], v1, s[48:51], s30 offen sc1
    v_and_b32 v6, 3, v0
    v_lshlrev_b32 v6, 6, v6
    v_lshrrev_b32 v7, 2, v0
    v_lshl_add_u32 v6, v7, 13, v6
    s_lshl_b32 s30, s56, 8
    s_lshl3_add_u32 s30, s54, s30
    s_add_u32 s30, s30, 1310720
    buffer_store_dwordx2 v[32:33], v6, s[48:51], s30 offen sc1
    v_and_b32 v6, 3, v0
    v_lshlrev_b32 v6, 3, v6
    v_mul_u32_u24 v7, 6144, v7
    v_add_u32 v6, v6, v7
    s_mul_i32 s30, s55, 24
    s_add_u32 s30, s30, 1490944
    s_mov_b64 exec, 0x77
    buffer_store_dwordx2 v[32:33], v6, s[48:51], s30 offen sc1
    s_mov_b64 exec, -1
L_ncl:
L_ncl2:
    s_cmp_lt_u32 s3, 4
    s_cbranch_scc1 L_nwl
    s_sub_u32 s30, s3, 1
    s_lshl_b32 s30, s30, 9
    v_lshl_add_u32 v4, v0, 3, s30
    global_load_dwordx2 v[100:101], v4, s[16:17]
    global_load_dwordx2 v[102:103], v4, s[18:19]
    global_load_dwordx2 v[104:105], v4, s[20:21]
L_nwl:
    s_barrier
    s_mov_b32 s31, 1515520
    s_load_dwordx2 s[100:101], s[28:29], s31
    s_cmp_lt_u32 s3, 4
    s_cbranch_scc1 L_loads
    s_waitcnt lgkmcnt(0)
    s_andn2_b32 s100, s100, 15
    s_add_u32 s100, s100, 16
    s_addc_u32 s101, s101, 0
    s_getreg_b32 s30, hwreg(HW_REG_XCC_ID,0,4)
    s_or_b32 s100, s100, s30
    s_waitcnt vmcnt(0)
L_table:
    v_lshlrev_b32 v88, 16, v100
    v_and_b32 v89, 0xffff0000, v100
    v_lshlrev_b32 v90, 16, v101
    v_and_b32 v91, 0xffff0000, v101
    v_lshlrev_b32 v92, 16, v102
    v_and_b32 v93, 0xffff0000, v102
    v_lshlrev_b32 v94, 16, v103
    v_and_b32 v95, 0xffff0000, v103
    v_lshlrev_b32 v96, 16, v104
    v_and_b32 v97, 0xffff0000, v104
    v_lshlrev_b32 v98, 16, v105
    v_and_b32 v99, 0xffff0000, v105
    v_mov_b32 v124, 0xc0135761
    v_mov_b32 v125, 0xbdd2d3e8
    v_mov_b32 v126, 1.0
    s_mul_i32 s30, s55, 12
    s_add_u32 s30, s30, 13824
    s_lshl_b32 s84, s30, 16
    s_add_u32 s85, s84, 65536
    s_add_u32 s86, s84, 131072
    s_add_u32 s87, s84, 196608
    s_add_u32 s88, s84, 262144
    s_add_u32 s89, s84, 327680
    s_add_u32 s90, s84, 393216
    s_add_u32 s91, s84, 458752
    s_add_u32 s92, s84, 524288
    s_add_u32 s93, s84, 589824
    s_add_u32 s94, s84, 655360
    s_add_u32 s95, s84, 720896
    v_mov_b32 v107, 0
    s_cmp_eq_u32 s3, 1
    s_cselect_b64 exec, 1, 0
    v_lshlrev_b32 v107, 16, v106
    s_mov_b64 exec, -1
    v_mov_b32 v64, v107
    v_mov_b32 v65, v107
    v_mov_b32 v66, v107
    v_mov_b32 v67, v107
    v_mov_b32 v68, v107
    v_mov_b32 v69, v107
    v_mov_b32 v70, v107
    v_mov_b32 v71, v107
    v_mov_b32 v72, v107
    v_mov_b32 v73, v107
    v_mov_b32 v74, v107
    v_mov_b32 v75, v107
    v_mov_b32 v76, v107
    v_mov_b32 v77, v107
    v_mov_b32 v78, v107
    v_mov_b32 v79, v107
    v_mov_b32 v80, v107
    v_mov_b32 v81, v107
    v_mov_b32 v82, v107
    v_mov_b32 v83, v107
    v_mov_b32 v84, v107
    v_mov_b32 v85, v107
    v_mov_b32 v86, v107
    v_mov_b32 v87, v107
    s_mov_b32 s30, 4
L_tloop:
    v_pk_fma_f32 v[100:101], s[84:85], v[88:89], v[92:93] op_sel:[0,0,0] op_sel_hi:[0,0,0] neg_hi:[1,0,0]
    v_pk_fma_f32 v[102:103], s[84:85], v[88:89], v[92:93] op_sel:[1,0,0] op_sel_hi:[1,0,0] neg_hi:[1,0,0]
    v_pk_fma_f32 v[104:105], s[86:87], v[88:89], v[92:93] op_sel:[0,0,0] op_sel_hi:[0,0,0] neg_hi:[1,0,0]
    v_pk_fma_f32 v[106:107], s[86:87], v[88:89], v[92:93] op_sel:[1,0,0] op_sel_hi:[1,0,0] neg_hi:[1,0,0]
    v_pk_mul_f32 v[108:109], v[100:101], v[100:101]
    v_pk_mul_f32 v[110:111], v[102:103], v[102:103]
    v_pk_mul_f32 v[112:113], v[104:105], v[104:105]
    v_pk_mul_f32 v[114:115], v[106:107], v[106:107]
    v_pk_fma_f32 v[108:109], v[108:109], v[124:125], v[124:125] op_sel:[0,1,0] op_sel_hi:[1,1,0]
    v_pk_fma_f32 v[110:111], v[110:111], v[124:125], v[124:125] op_sel:[0,1,0] op_sel_hi:[1,1,0]
    v_pk_fma_f32 v[112:113], v[112:113], v[124:125], v[124:125] op_sel:[0,1,0] op_sel_hi:[1,1,0]
    v_pk_fma_f32 v[114:115], v[114:115], v[124:125], v[124:125] op_sel:[0,1,0] op_sel_hi:[1,1,0]
    v_pk_mul_f32 v[108:109], v[108:109], v[100:101]
    v_pk_mul_f32 v[110:111], v[110:111], v[102:103]
    v_pk_mul_f32 v[112:113], v[112:113], v[104:105]
    v_pk_mul_f32 v[114:115], v[114:115], v[106:107]
    v_exp_f32 v108, v108
    v_exp_f32 v109, v109
    v_exp_f32 v110, v110
    v_exp_f32 v111, v111
    v_exp_f32 v112, v112
    v_exp_f32 v113, v113
    v_exp_f32 v114, v114
    v_exp_f32 v115, v115
    v_pk_add_f32 v[108:109], v[108:109], v[126:127] op_sel_hi:[1,0]
    v_pk_add_f32 v[110:111], v[110:111], v[126:127] op_sel_hi:[1,0]
    v_pk_add_f32 v[112:113], v[112:113], v[126:127] op_sel_hi:[1,0]
    v_pk_add_f32 v[114:115], v[114:115], v[126:127] op_sel_hi:[1,0]
    v_rcp_f32 v108, v108
    v_rcp_f32 v109, v109
    v_rcp_f32 v110, v110
    v_rcp_f32 v111, v111
    v_rcp_f32 v112, v112
    v_rcp_f32 v113, v113
    v_rcp_f32 v114, v114
    v_rcp_f32 v115, v115
    v_pk_mul_f32 v[108:109], v[108:109], v[100:101]
    v_pk_mul_f32 v[110:111], v[110:111], v[102:103]
    v_pk_mul_f32 v[112:113], v[112:113], v[104:105]
    v_pk_mul_f32 v[114:115], v[114:115], v[106:107]
    v_pk_fma_f32 v[64:65], v[108:109], v[96:97], v[64:65] op_sel_hi:[1,0,1]
    v_pk_fma_f32 v[66:67], v[110:111], v[96:97], v[66:67] op_sel_hi:[1,0,1]
    v_pk_fma_f32 v[68:69], v[112:113], v[96:97], v[68:69] op_sel_hi:[1,0,1]
    v_pk_fma_f32 v[70:71], v[114:115], v[96:97], v[70:71] op_sel_hi:[1,0,1]
    v_pk_fma_f32 v[100:101], s[88:89], v[88:89], v[92:93] op_sel:[0,0,0] op_sel_hi:[0,0,0] neg_hi:[1,0,0]
    v_pk_fma_f32 v[102:103], s[88:89], v[88:89], v[92:93] op_sel:[1,0,0] op_sel_hi:[1,0,0] neg_hi:[1,0,0]
    v_pk_fma_f32 v[104:105], s[90:91], v[88:89], v[92:93] op_sel:[0,0,0] op_sel_hi:[0,0,0] neg_hi:[1,0,0]
    v_pk_fma_f32 v[106:107], s[90:91], v[88:89], v[92:93] op_sel:[1,0,0] op_sel_hi:[1,0,0] neg_hi:[1,0,0]
    v_pk_mul_f32 v[108:109], v[100:101], v[100:101]
    v_pk_mul_f32 v[110:111], v[102:103], v[102:103]
    v_pk_mul_f32 v[112:113], v[104:105], v[104:105]
    v_pk_mul_f32 v[114:115], v[106:107], v[106:107]
    v_pk_fma_f32 v[108:109], v[108:109], v[124:125], v[124:125] op_sel:[0,1,0] op_sel_hi:[1,1,0]
    v_pk_fma_f32 v[110:111], v[110:111], v[124:125], v[124:125] op_sel:[0,1,0] op_sel_hi:[1,1,0]
    v_pk_fma_f32 v[112:113], v[112:113], v[124:125], v[124:125] op_sel:[0,1,0] op_sel_hi:[1,1,0]
    v_pk_fma_f32 v[114:115], v[114:115], v[124:125], v[124:125] op_sel:[0,1,0] op_sel_hi:[1,1,0]
    v_pk_mul_f32 v[108:109], v[108:109], v[100:101]
    v_pk_mul_f32 v[110:111], v[110:111], v[102:103]
    v_pk_mul_f32 v[112:113], v[112:113], v[104:105]
    v_pk_mul_f32 v[114:115], v[114:115], v[106:107]
    v_exp_f32 v108, v108
    v_exp_f32 v109, v109
    v_exp_f32 v110, v110
    v_exp_f32 v111, v111
    v_exp_f32 v112, v112
    v_exp_f32 v113, v113
    v_exp_f32 v114, v114
    v_exp_f32 v115, v115
    v_pk_add_f32 v[108:109], v[108:109], v[126:127] op_sel_hi:[1,0]
    v_pk_add_f32 v[110:111], v[110:111], v[126:127] op_sel_hi:[1,0]
    v_pk_add_f32 v[112:113], v[112:113], v[126:127] op_sel_hi:[1,0]
    v_pk_add_f32 v[114:115], v[114:115], v[126:127] op_sel_hi:[1,0]
    v_rcp_f32 v108, v108
    v_rcp_f32 v109, v109
    v_rcp_f32 v110, v110
    v_rcp_f32 v111, v111
    v_rcp_f32 v112, v112
    v_rcp_f32 v113, v113
    v_rcp_f32 v114, v114
    v_rcp_f32 v115, v115
    v_pk_mul_f32 v[108:109], v[108:109], v[100:101]
    v_pk_mul_f32 v[110:111], v[110:111], v[102:103]
    v_pk_mul_f32 v[112:113], v[112:113], v[104:105]
    v_pk_mul_f32 v[114:115], v[114:115], v[106:107]
    v_pk_fma_f32 v[72:73], v[108:109], v[96:97], v[72:73] op_sel_hi:[1,0,1]
    v_pk_fma_f32 v[74:75], v[110:111], v[96:97], v[74:75] op_sel_hi:[1,0,1]
    v_pk_fma_f32 v[76:77], v[112:113], v[96:97], v[76:77] op_sel_hi:[1,0,1]
    v_pk_fma_f32 v[78:79], v[114:115], v[96:97], v[78:79] op_sel_hi:[1,0,1]
    v_pk_fma_f32 v[100:101], s[92:93], v[88:89], v[92:93] op_sel:[0,0,0] op_sel_hi:[0,0,0] neg_hi:[1,0,0]
    v_pk_fma_f32 v[102:103], s[92:93], v[88:89], v[92:93] op_sel:[1,0,0] op_sel_hi:[1,0,0] neg_hi:[1,0,0]
    v_pk_fma_f32 v[104:105], s[94:95], v[88:89], v[92:93] op_sel:[0,0,0] op_sel_hi:[0,0,0] neg_hi:[1,0,0]
    v_pk_fma_f32 v[106:107], s[94:95], v[88:89], v[92:93] op_sel:[1,0,0] op_sel_hi:[1,0,0] neg_hi:[1,0,0]
    v_pk_mul_f32 v[108:109], v[100:101], v[100:101]
    v_pk_mul_f32 v[110:111], v[102:103], v[102:103]
    v_pk_mul_f32 v[112:113], v[104:105], v[104:105]
    v_pk_mul_f32 v[114:115], v[106:107], v[106:107]
    v_pk_fma_f32 v[108:109], v[108:109], v[124:125], v[124:125] op_sel:[0,1,0] op_sel_hi:[1,1,0]
    v_pk_fma_f32 v[110:111], v[110:111], v[124:125], v[124:125] op_sel:[0,1,0] op_sel_hi:[1,1,0]
    v_pk_fma_f32 v[112:113], v[112:113], v[124:125], v[124:125] op_sel:[0,1,0] op_sel_hi:[1,1,0]
    v_pk_fma_f32 v[114:115], v[114:115], v[124:125], v[124:125] op_sel:[0,1,0] op_sel_hi:[1,1,0]
    v_pk_mul_f32 v[108:109], v[108:109], v[100:101]
    v_pk_mul_f32 v[110:111], v[110:111], v[102:103]
    v_pk_mul_f32 v[112:113], v[112:113], v[104:105]
    v_pk_mul_f32 v[114:115], v[114:115], v[106:107]
    v_exp_f32 v108, v108
    v_exp_f32 v109, v109
    v_exp_f32 v110, v110
    v_exp_f32 v111, v111
    v_exp_f32 v112, v112
    v_exp_f32 v113, v113
    v_exp_f32 v114, v114
    v_exp_f32 v115, v115
    v_pk_add_f32 v[108:109], v[108:109], v[126:127] op_sel_hi:[1,0]
    v_pk_add_f32 v[110:111], v[110:111], v[126:127] op_sel_hi:[1,0]
    v_pk_add_f32 v[112:113], v[112:113], v[126:127] op_sel_hi:[1,0]
    v_pk_add_f32 v[114:115], v[114:115], v[126:127] op_sel_hi:[1,0]
    v_rcp_f32 v108, v108
    v_rcp_f32 v109, v109
    v_rcp_f32 v110, v110
    v_rcp_f32 v111, v111
    v_rcp_f32 v112, v112
    v_rcp_f32 v113, v113
    v_rcp_f32 v114, v114
    v_rcp_f32 v115, v115
    v_pk_mul_f32 v[108:109], v[108:109], v[100:101]
    v_pk_mul_f32 v[110:111], v[110:111], v[102:103]
    v_pk_mul_f32 v[112:113], v[112:113], v[104:105]
    v_pk_mul_f32 v[114:115], v[114:115], v[106:107]
    v_pk_fma_f32 v[80:81], v[108:109], v[96:97], v[80:81] op_sel_hi:[1,0,1]
    v_pk_fma_f32 v[82:83], v[110:111], v[96:97], v[82:83] op_sel_hi:[1,0,1]
    v_pk_fma_f32 v[84:85], v[112:113], v[96:97], v[84:85] op_sel_hi:[1,0,1]
    v_pk_fma_f32 v[86:87], v[114:115], v[96:97], v[86:87] op_sel_hi:[1,0,1]
    v_mov_b32 v88, v89
    v_mov_b32 v89, v90
    v_mov_b32 v90, v91
    v_mov_b32 v92, v93
    v_mov_b32 v93, v94
    v_mov_b32 v94, v95
    v_mov_b32 v96, v97
    v_mov_b32 v97, v98
    v_mov_b32 v98, v99
    s_sub_u32 s30, s30, 1
    s_cmp_lg_u32 s30, 0
    s_cbranch_scc1 L_tloop
    v_permlane32_swap_b32 v64, v76
    v_permlane32_swap_b32 v65, v77
    v_permlane32_swap_b32 v66, v78
    v_permlane32_swap_b32 v67, v79
    v_permlane32_swap_b32 v68, v80
    v_permlane32_swap_b32 v69, v81
    v_permlane32_swap_b32 v70, v82
    v_permlane32_swap_b32 v71, v83
    v_permlane32_swap_b32 v72, v84
    v_permlane32_swap_b32 v73, v85
    v_permlane32_swap_b32 v74, v86
    v_permlane32_swap_b32 v75, v87
    v_add_f32 v64, v64, v76
    v_add_f32 v65, v65, v77
    v_add_f32 v66, v66, v78
    v_add_f32 v67, v67, v79
    v_add_f32 v68, v68, v80
    v_add_f32 v69, v69, v81
    v_add_f32 v70, v70, v82
    v_add_f32 v71, v71, v83
    v_add_f32 v72, v72, v84
    v_add_f32 v73, v73, v85
    v_add_f32 v74, v74, v86
    v_add_f32 v75, v75, v87
    v_permlane16_swap_b32 v64, v70
    v_permlane16_swap_b32 v65, v71
    v_permlane16_swap_b32 v66, v72
    v_permlane16_swap_b32 v67, v73
    v_permlane16_swap_b32 v68, v74
    v_permlane16_swap_b32 v69, v75
    v_add_f32 v64, v64, v70
    v_add_f32 v65, v65, v71
    v_add_f32 v66, v66, v72
    v_add_f32 v67, v67, v73
    v_add_f32 v68, v68, v74
    v_add_f32 v69, v69, v75
    v_add_f32_dpp v64, v64, v64 quad_perm:[1,0,3,2] row_mask:0xf bank_mask:0xf
    v_add_f32_dpp v65, v65, v65 quad_perm:[1,0,3,2] row_mask:0xf bank_mask:0xf
    v_add_f32_dpp v66, v66, v66 quad_perm:[1,0,3,2] row_mask:0xf bank_mask:0xf
    v_add_f32_dpp v67, v67, v67 quad_perm:[1,0,3,2] row_mask:0xf bank_mask:0xf
    v_add_f32_dpp v68, v68, v68 quad_perm:[1,0,3,2] row_mask:0xf bank_mask:0xf
    v_add_f32_dpp v69, v69, v69 quad_perm:[1,0,3,2] row_mask:0xf bank_mask:0xf
    v_add_f32_dpp v64, v64, v64 quad_perm:[2,3,0,1] row_mask:0xf bank_mask:0xf
    v_add_f32_dpp v65, v65, v65 quad_perm:[2,3,0,1] row_mask:0xf bank_mask:0xf
    v_add_f32_dpp v66, v66, v66 quad_perm:[2,3,0,1] row_mask:0xf bank_mask:0xf
    v_add_f32_dpp v67, v67, v67 quad_perm:[2,3,0,1] row_mask:0xf bank_mask:0xf
    v_add_f32_dpp v68, v68, v68 quad_perm:[2,3,0,1] row_mask:0xf bank_mask:0xf
    v_add_f32_dpp v69, v69, v69 quad_perm:[2,3,0,1] row_mask:0xf bank_mask:0xf
    v_add_f32_dpp v64, v64, v64 row_half_mirror row_mask:0xf bank_mask:0xf
    v_add_f32_dpp v65, v65, v65 row_half_mirror row_mask:0xf bank_mask:0xf
    v_add_f32_dpp v66, v66, v66 row_half_mirror row_mask:0xf bank_mask:0xf
    v_add_f32_dpp v67, v67, v67 row_half_mirror row_mask:0xf bank_mask:0xf
    v_add_f32_dpp v68, v68, v68 row_half_mirror row_mask:0xf bank_mask:0xf
    v_add_f32_dpp v69, v69, v69 row_half_mirror row_mask:0xf bank_mask:0xf
    v_add_f32_dpp v64, v64, v64 row_mirror row_mask:0xf bank_mask:0xf
    v_add_f32_dpp v65, v65, v65 row_mirror row_mask:0xf bank_mask:0xf
    v_add_f32_dpp v66, v66, v66 row_mirror row_mask:0xf bank_mask:0xf
    v_add_f32_dpp v67, v67, v67 row_mirror row_mask:0xf bank_mask:0xf
    v_add_f32_dpp v68, v68, v68 row_mirror row_mask:0xf bank_mask:0xf
    v_add_f32_dpp v69, v69, v69 row_mirror row_mask:0xf bank_mask:0xf
    s_mul_i32 s30, s3, 96
    s_add_u32 s30, s30, 162720
    v_mul_u32_u24 v4, 24, v2
    v_add_u32 v4, s30, v4
    s_mov_b32 exec_lo, 0x00010001
    s_mov_b32 exec_hi, 0x00010001
    ds_write_b64 v4, v[64:65]
    ds_write_b64 v4, v[66:67] offset:8
    ds_write_b64 v4, v[68:69] offset:16
    s_mov_b64 exec, -1
    s_cmp_lt_u32 s3, 4
    s_cbranch_scc1 L_B1
    s_branch L_gw0
L_loads:
    s_xor_b32 s84, s80, 0
    s_xor_b32 s85, s80, 1024
    s_xor_b32 s86, s80, 2048
    s_xor_b32 s87, s80, 3072
    s_xor_b32 s88, s80, 4096
    s_xor_b32 s89, s80, 5120
    s_xor_b32 s90, s80, 6144
    s_xor_b32 s91, s80, 7168
    s_xor_b32 s92, s80, 8192
    s_xor_b32 s93, s80, 9216
    s_xor_b32 s94, s80, 10240
    s_xor_b32 s95, s80, 11264
    s_xor_b32 s96, s80, 12288
    s_xor_b32 s97, s80, 13312
    s_xor_b32 s98, s80, 14336
    s_xor_b32 s99, s80, 15360
    buffer_load_dwordx4 v[128:131], v1, s[32:35], s84 offen nt
    buffer_load_dwordx4 v[132:135], v1, s[32:35], s85 offen nt
    buffer_load_dwordx4 v[136:139], v1, s[32:35], s86 offen nt
    buffer_load_dwordx4 v[140:143], v1, s[32:35], s87 offen nt
    buffer_load_dwordx4 v[144:147], v1, s[32:35], s88 offen nt
    buffer_load_dwordx4 v[148:151], v1, s[32:35], s89 offen nt
    buffer_load_dwordx4 v[152:155], v1, s[32:35], s90 offen nt
    buffer_load_dwordx4 v[156:159], v1, s[32:35], s91 offen nt
    buffer_load_dwordx4 v[160:163], v1, s[32:35], s92 offen nt
    buffer_load_dwordx4 v[164:167], v1, s[32:35], s93 offen nt
    buffer_load_dwordx4 v[168:171], v1, s[32:35], s94 offen nt
    buffer_load_dwordx4 v[172:175], v1, s[32:35], s95 offen nt
    buffer_load_dwordx4 v[176:179], v1, s[32:35], s96 offen nt
    buffer_load_dwordx4 v[180:183], v1, s[32:35], s97 offen nt
    buffer_load_dwordx4 v[184:187], v1, s[32:35], s98 offen nt
    buffer_load_dwordx4 v[188:191], v1, s[32:35], s99 offen nt
    s_sub_u32 s30, s3, 1
    s_lshl_b32 s30, s30, 9
    v_lshl_add_u32 v4, v0, 3, s30
    global_load_dwordx2 v[100:101], v4, s[16:17]
    global_load_dwordx2 v[102:103], v4, s[18:19]
    global_load_dwordx2 v[104:105], v4, s[20:21]
    s_cmp_lg_u32 s3, 1
    s_cbranch_scc1 L_nb2
    v_mov_b32 v5, 0
    global_load_ushort v106, v5, s[22:23]
L_nb2:
    s_waitcnt lgkmcnt(0)
    s_andn2_b32 s100, s100, 15
    s_add_u32 s100, s100, 16
    s_addc_u32 s101, s101, 0
    s_getreg_b32 s30, hwreg(HW_REG_XCC_ID,0,4)
    s_or_b32 s100, s100, s30
    s_cmp_lg_u32 s3, 3
    s_cbranch_scc1 L_nfb
    s_lshl_b32 s30, s56, 7
    s_lshl3_add_u32 s30, s54, s30
    s_add_u32 s30, s30, 1507328
    v_mov_b32 v4, s100
    v_mov_b32 v5, s101
    s_mov_b64 exec, 1
    s_waitcnt vmcnt(19)
    buffer_store_dwordx2 v[4:5], v1, s[48:51], s30 offen sc1
    v_mov_b32 v6, 163584
    v_mov_b32 v7, 1
    ds_add_u32 v6, v7 offset:16
    s_mov_b64 exec, -1
L_nfb:
L_gw0:
    v_mov_b32 v16, 163584
    s_mov_b32 s59, 262144
L_gw:
    s_nop 15
    ds_read_b32 v17, v16 offset:16
    s_waitcnt lgkmcnt(0)
    v_readfirstlane_b32 s30, v17
    s_sub_u32 s59, s59, 1
    s_cbranch_scc1 L_gwk
    s_cmp_lt_u32 s30, 2
    s_cbranch_scc1 L_gw
L_gwk:
L_kld:
    s_sub_u32 s30, s3, 1
    s_cmp_lt_u32 s30, 3
    s_cbranch_scc1 L_kld2
    s_and_b32 s31, s3, 3
    v_bfe_u32 v18, v0, 3, 2
    v_xor_b32 v18, s31, v18
    v_lshlrev_b32 v18, 5, v18
    v_and_b32 v19, 3, v0
    v_lshl_add_u32 v18, v19, 3, v18
    v_bfe_u32 v19, v0, 2, 2
    v_lshl_add_u32 v18, v19, 7, v18
    v_lshl_add_u32 v18, v2, 10, v18
    v_add_u32 v18, 139264, v18
    ds_read_b64_tr_b16 v[64:65], v18 offset:0
    ds_read_b64_tr_b16 v[66:67], v18 offset:512
    ds_read_b64_tr_b16 v[68:69], v18 offset:4096
    ds_read_b64_tr_b16 v[70:71], v18 offset:4608
    ds_read_b64_tr_b16 v[72:73], v18 offset:8192
    ds_read_b64_tr_b16 v[74:75], v18 offset:8704
    ds_read_b64_tr_b16 v[76:77], v18 offset:12288
    ds_read_b64_tr_b16 v[78:79], v18 offset:12800
    v_mov_b32 v19, 1
    s_mov_b64 exec, 1
    ds_add_u32 v16, v19 offset:20
    s_mov_b64 exec, -1
    s_lshl_b32 s30, s52, 10
    s_lshl_b32 s31, s3, 8
    s_add_u32 s30, s30, s31
    s_sub_u32 s30, s30, 1024
    v_lshl_add_u32 v4, v0, 2, s30
    global_load_dword v12, v4, s[4:5]
    s_xor_b32 s84, s80, 0
    s_xor_b32 s85, s80, 1024
    s_xor_b32 s86, s80, 2048
    s_xor_b32 s87, s80, 3072
    s_xor_b32 s88, s80, 4096
    s_xor_b32 s89, s80, 5120
    s_xor_b32 s90, s80, 6144
    s_xor_b32 s91, s80, 7168
    s_xor_b32 s92, s80, 8192
    s_xor_b32 s93, s80, 9216
    s_xor_b32 s94, s80, 10240
    s_xor_b32 s95, s80, 11264
    s_xor_b32 s96, s80, 12288
    s_xor_b32 s97, s80, 13312
    s_xor_b32 s98, s80, 14336
    s_xor_b32 s99, s80, 15360
    buffer_load_dwordx4 v[128:131], v1, s[32:35], s84 offen nt
    buffer_load_dwordx4 v[132:135], v1, s[32:35], s85 offen nt
    buffer_load_dwordx4 v[136:139], v1, s[32:35], s86 offen nt
    buffer_load_dwordx4 v[140:143], v1, s[32:35], s87 offen nt
    buffer_load_dwordx4 v[144:147], v1, s[32:35], s88 offen nt
    buffer_load_dwordx4 v[148:151], v1, s[32:35], s89 offen nt
    buffer_load_dwordx4 v[152:155], v1, s[32:35], s90 offen nt
    buffer_load_dwordx4 v[156:159], v1, s[32:35], s91 offen nt
    buffer_load_dwordx4 v[160:163], v1, s[32:35], s92 offen nt
    buffer_load_dwordx4 v[164:167], v1, s[32:35], s93 offen nt
    buffer_load_dwordx4 v[168:171], v1, s[32:35], s94 offen nt
    buffer_load_dwordx4 v[172:175], v1, s[32:35], s95 offen nt
    buffer_load_dwordx4 v[176:179], v1, s[32:35], s96 offen nt
    buffer_load_dwordx4 v[180:183], v1, s[32:35], s97 offen nt
    buffer_load_dwordx4 v[184:187], v1, s[32:35], s98 offen nt
    buffer_load_dwordx4 v[188:191], v1, s[32:35], s99 offen nt
L_kld2:
L_vld:
    s_cmp_lt_u32 s3, 4
    s_cbranch_scc1 L_vld2
    s_mul_i32 s30, s3, 9216
    s_add_u32 s30, s30, 65536
    v_mul_u32_u24 v16, 272, v2
    v_lshl_add_u32 v16, v3, 4, v16
    v_add_u32 v16, s30, v16
    v_mul_u32_u24 v17, 272, v3
    v_lshl_add_u32 v17, v2, 4, v17
    v_add_u32 v17, s30, v17
    s_waitcnt vmcnt(8)
    ds_write_b128 v16, v[128:131] offset:0
    ds_write_b128 v16, v[132:135] offset:1088
    ds_write_b128 v16, v[136:139] offset:2176
    ds_write_b128 v16, v[140:143] offset:3264
    ds_write_b128 v16, v[144:147] offset:4352
    ds_write_b128 v16, v[148:151] offset:5440
    ds_write_b128 v16, v[152:155] offset:6528
    ds_write_b128 v16, v[156:159] offset:7616
    ds_read_b128 v[128:131], v17 offset:0
    ds_read_b128 v[132:135], v17 offset:64
    ds_read_b128 v[136:139], v17 offset:128
    ds_read_b128 v[140:143], v17 offset:192
    ds_read_b128 v[144:147], v17 offset:4352
    ds_read_b128 v[148:151], v17 offset:4416
    ds_read_b128 v[152:155], v17 offset:4480
    ds_read_b128 v[156:159], v17 offset:4544
    s_waitcnt vmcnt(0)
    ds_write_b128 v16, v[160:163] offset:0
    ds_write_b128 v16, v[164:167] offset:1088
    ds_write_b128 v16, v[168:171] offset:2176
    ds_write_b128 v16, v[172:175] offset:3264
    ds_write_b128 v16, v[176:179] offset:4352
    ds_write_b128 v16, v[180:183] offset:5440
    ds_write_b128 v16, v[184:187] offset:6528
    ds_write_b128 v16, v[188:191] offset:7616
    ds_read_b128 v[160:163], v17 offset:0
    ds_read_b128 v[164:167], v17 offset:64
    ds_read_b128 v[168:171], v17 offset:128
    ds_read_b128 v[172:175], v17 offset:192
    ds_read_b128 v[176:179], v17 offset:4352
    ds_read_b128 v[180:183], v17 offset:4416
    ds_read_b128 v[184:187], v17 offset:4480
    ds_read_b128 v[188:191], v17 offset:4544
L_vld2:
    buffer_load_dwordx4 v[192:195], v1, s[36:39], s84 offen nt
    buffer_load_dwordx4 v[196:199], v1, s[36:39], s85 offen nt
    buffer_load_dwordx4 v[200:203], v1, s[36:39], s86 offen nt
    buffer_load_dwordx4 v[204:207], v1, s[36:39], s87 offen nt
    buffer_load_dwordx4 v[208:211], v1, s[36:39], s88 offen nt
    buffer_load_dwordx4 v[212:215], v1, s[36:39], s89 offen nt
    buffer_load_dwordx4 v[216:219], v1, s[36:39], s90 offen nt
    buffer_load_dwordx4 v[220:223], v1, s[36:39], s91 offen nt
    buffer_load_dwordx4 v[224:227], v1, s[36:39], s92 offen nt
    buffer_load_dwordx4 v[228:231], v1, s[36:39], s93 offen nt
    buffer_load_dwordx4 v[232:235], v1, s[36:39], s94 offen nt
    buffer_load_dwordx4 v[236:239], v1, s[36:39], s95 offen nt
    buffer_load_dwordx4 v[240:243], v1, s[36:39], s96 offen nt
    buffer_load_dwordx4 v[244:247], v1, s[36:39], s97 offen nt
    buffer_load_dwordx4 v[248:251], v1, s[36:39], s98 offen nt
    buffer_load_dwordx4 v[252:255], v1, s[36:39], s99 offen nt
L_vld3:
    s_cmp_eq_u32 s3, 0
    s_cbranch_scc1 L_poll
    s_cmp_lt_u32 s3, 4
    s_cbranch_scc0 L_nt2
    s_waitcnt vmcnt(16)
    s_branch L_table
L_nt2:
    s_waitcnt vmcnt(32)
    s_cmp_lt_u32 s3, 4
    s_cbranch_scc1 L_table
    v_lshlrev_b32 v8, 16, v12
    v_and_b32 v9, 0xffff0000, v12
    v_mov_b32 v4, 163584
    v_mov_b32 v5, 1
    s_mov_b64 exec, 1
    ds_add_u32 v4, v5 offset:12
    s_mov_b64 exec, -1
L_B1:
    s_mov_b32 s57, 0
    s_cmp_lg_u32 s3, 1
    s_cbranch_scc1 L_nfi
    v_lshrrev_b32 v120, 1, v0
    v_lshlrev_b32 v120, 6, v120
    v_lshl_add_u32 v120, v0, 5, v120
    s_mov_b32 s61, 1507328
    buffer_load_dwordx4 v[112:115], v120, s[48:51], s61 offen sc1
    buffer_load_dwordx4 v[116:119], v120, s[48:51], s61 offen offset:16 sc1
L_nfi:
    v_and_b32 v16, 3, v3
    v_mul_u32_u24 v4, 320, v16
    v_lshl_add_u32 v4, v2, 4, v4
    v_add_u32 v4, 158464, v4
    s_mul_i32 s30, s3, 2368
    s_add_u32 s30, s30, 139264
    v_mul_u32_u24 v5, 592, v16
    v_lshl_add_u32 v5, v2, 4, v5
    v_add_u32 v5, s30, v5
    v_lshlrev_b32 v6, 4, v2
    v_add_u32 v6, 159744, v6
    v_and_b32 v17, 1, v3
    v_lshl_add_u32 v6, v17, 6, v6
    s_and_b32 s31, s3, 3
    v_bfe_u32 v7, v0, 3, 2
    v_xor_b32 v7, s31, v7
    v_lshlrev_b32 v7, 5, v7
    v_and_b32 v16, 3, v0
    v_lshl_add_u32 v7, v16, 3, v7
    v_bfe_u32 v16, v0, 2, 2
    v_lshl_add_u32 v7, v16, 7, v7
    v_lshl_add_u32 v7, v2, 10, v7
    s_cmp_lt_u32 s3, 4
    s_cbranch_scc0 L_nkr
    s_mul_i32 s30, s3, 9216
    s_add_u32 s30, s30, 65536
    v_mul_u32_u24 v16, 272, v2
    v_lshl_add_u32 v16, v3, 4, v16
    v_add_u32 v16, s30, v16
    v_mul_u32_u24 v17, 272, v3
    v_lshl_add_u32 v17, v2, 4, v17
    v_add_u32 v17, s30, v17
    s_waitcnt vmcnt(24)
    ds_write_b128 v16, v[128:131] offset:0
    ds_write_b128 v16, v[132:135] offset:1088
    ds_write_b128 v16, v[136:139] offset:2176
    ds_write_b128 v16, v[140:143] offset:3264
    ds_write_b128 v16, v[144:147] offset:4352
    ds_write_b128 v16, v[148:151] offset:5440
    ds_write_b128 v16, v[152:155] offset:6528
    ds_write_b128 v16, v[156:159] offset:7616
    ds_read_b128 v[128:131], v17 offset:0
    ds_read_b128 v[132:135], v17 offset:64
    ds_read_b128 v[136:139], v17 offset:128
    ds_read_b128 v[140:143], v17 offset:192
    ds_read_b128 v[144:147], v17 offset:4352
    ds_read_b128 v[148:151], v17 offset:4416
    ds_read_b128 v[152:155], v17 offset:4480
    ds_read_b128 v[156:159], v17 offset:4544
    s_waitcnt vmcnt(16)
    ds_write_b128 v16, v[160:163] offset:0
    ds_write_b128 v16, v[164:167] offset:1088
    ds_write_b128 v16, v[168:171] offset:2176
    ds_write_b128 v16, v[172:175] offset:3264
    ds_write_b128 v16, v[176:179] offset:4352
    ds_write_b128 v16, v[180:183] offset:5440
    ds_write_b128 v16, v[184:187] offset:6528
    ds_write_b128 v16, v[188:191] offset:7616
    ds_read_b128 v[160:163], v17 offset:0
    ds_read_b128 v[164:167], v17 offset:64
    ds_read_b128 v[168:171], v17 offset:128
    ds_read_b128 v[172:175], v17 offset:192
    ds_read_b128 v[176:179], v17 offset:4352
    ds_read_b128 v[180:183], v17 offset:4416
    ds_read_b128 v[184:187], v17 offset:4480
    ds_read_b128 v[188:191], v17 offset:4544
L_nkr:
    s_mul_i32 s30, s3, 9216
    s_add_u32 s30, s30, 65536
    v_mul_u32_u24 v60, 288, v2
    v_lshl_add_u32 v60, v3, 4, v60
    v_add_u32 v60, s30, v60
    v_lshrrev_b32 v61, 2, v0
    v_mul_u32_u24 v61, 288, v61
    v_and_b32 v62, 3, v0
    v_lshl_add_u32 v61, v62, 3, v61
    v_add_u32 v61, s30, v61
    s_mov_b32 s60, 0
    s_cmp_lt_u32 s3, 4
    s_cbranch_scc0 L_nve
    s_waitcnt vmcnt(8)
    ds_write_b128 v60, v[192:195] offset:0
    ds_write_b128 v60, v[196:199] offset:1152
    ds_write_b128 v60, v[200:203] offset:2304
    ds_write_b128 v60, v[204:207] offset:3456
    ds_write_b128 v60, v[208:211] offset:4608
    ds_write_b128 v60, v[212:215] offset:5760
    ds_write_b128 v60, v[216:219] offset:6912
    ds_write_b128 v60, v[220:223] offset:8064
    ds_read_b64_tr_b16 v[192:193], v61 offset:0
    ds_read_b64_tr_b16 v[194:195], v61 offset:4608
    ds_read_b64_tr_b16 v[196:197], v61 offset:32
    ds_read_b64_tr_b16 v[198:199], v61 offset:4640
    ds_read_b64_tr_b16 v[200:201], v61 offset:64
    ds_read_b64_tr_b16 v[202:203], v61 offset:4672
    ds_read_b64_tr_b16 v[204:205], v61 offset:96
    ds_read_b64_tr_b16 v[206:207], v61 offset:4704
    ds_read_b64_tr_b16 v[208:209], v61 offset:128
    ds_read_b64_tr_b16 v[210:211], v61 offset:4736
    ds_read_b64_tr_b16 v[212:213], v61 offset:160
    ds_read_b64_tr_b16 v[214:215], v61 offset:4768
    ds_read_b64_tr_b16 v[216:217], v61 offset:192
    ds_read_b64_tr_b16 v[218:219], v61 offset:4800
    ds_read_b64_tr_b16 v[220:221], v61 offset:224
    ds_read_b64_tr_b16 v[222:223], v61 offset:4832
    s_waitcnt vmcnt(0)
    ds_write_b128 v60, v[224:227] offset:0
    ds_write_b128 v60, v[228:231] offset:1152
    ds_write_b128 v60, v[232:235] offset:2304
    ds_write_b128 v60, v[236:239] offset:3456
    ds_write_b128 v60, v[240:243] offset:4608
    ds_write_b128 v60, v[244:247] offset:5760
    ds_write_b128 v60, v[248:251] offset:6912
    ds_write_b128 v60, v[252:255] offset:8064
    ds_read_b64_tr_b16 v[224:225], v61 offset:0
    ds_read_b64_tr_b16 v[226:227], v61 offset:4608
    ds_read_b64_tr_b16 v[228:229], v61 offset:32
    ds_read_b64_tr_b16 v[230:231], v61 offset:4640
    ds_read_b64_tr_b16 v[232:233], v61 offset:64
    ds_read_b64_tr_b16 v[234:235], v61 offset:4672
    ds_read_b64_tr_b16 v[236:237], v61 offset:96
    ds_read_b64_tr_b16 v[238:239], v61 offset:4704
    ds_read_b64_tr_b16 v[240:241], v61 offset:128
    ds_read_b64_tr_b16 v[242:243], v61 offset:4736
    ds_read_b64_tr_b16 v[244:245], v61 offset:160
    ds_read_b64_tr_b16 v[246:247], v61 offset:4768
    ds_read_b64_tr_b16 v[248:249], v61 offset:192
    ds_read_b64_tr_b16 v[250:251], v61 offset:4800
    ds_read_b64_tr_b16 v[252:253], v61 offset:224
    ds_read_b64_tr_b16 v[254:255], v61 offset:4832
    s_mov_b32 s60, 1
L_nve:
    v_mov_b32 v56, 0x3f803f80
    v_mov_b32 v57, 0x3f803f80
    v_mov_b32 v58, 0x3f803f80
    v_mov_b32 v59, 0x3f803f80
    v_lshrrev_b32 v54, 2, v3
    v_lshlrev_b32 v55, v54, 1
    v_lshl_add_u32 v54, v54, 6, v5
    v_bfe_i32 v50, v55, 0, 1
    v_bfe_i32 v51, v55, 1, 1
    v_bfe_i32 v52, v55, 2, 1
    v_bfe_i32 v53, v55, 3, 1
    v_mov_b32 v55, 0x3e0293ee
    s_sub_u32 s96, s3, 4
    s_mul_i32 s30, s96, 592
    s_add_u32 s30, s30, 139264
    v_and_b32 v120, 0, v0
    v_mul_u32_u24 v120, 2368, v120
    v_add_u32 v120, s30, v120
    v_lshl_add_u32 v121, v0, 3, s30
    v_lshlrev_b32 v122, 3, v0
    v_and_b32 v123, 63, v122
    s_lshl_b32 s30, s96, 8
    s_add_u32 s30, s30, 159744
    v_lshl_add_u32 v124, v0, 2, s30
    s_lshl_b32 s97, s57, 19
    s_lshl_b32 s31, s56, 14
    s_add_u32 s97, s97, s31
    s_lshl_b32 s31, s96, 9
    s_add_u32 s97, s97, s31
    s_add_u32 s97, s97, 262144
    s_lshl_b32 s31, s54, 11
    s_add_u32 s92, s97, s31
    s_lshl_b32 s99, s57, 13
    s_lshl_b32 s31, s56, 8
    s_add_u32 s99, s99, s31
    s_lshl_b32 s31, s96, 6
    s_add_u32 s99, s99, s31
    s_add_u32 s99, s99, 1310720
    s_lshl3_add_u32 s93, s54, s99
    s_add_u32 s98, s97, 4096
    s_add_u32 s94, s97, 8192
    s_add_u32 s95, s97, 12288
    v_mov_b32 v16, 163584
    s_mov_b32 s59, 262144
L_qw:
    s_nop 15
    ds_read2_b32 v[18:19], v16 offset0:1 offset1:5
    s_waitcnt lgkmcnt(0)
    v_readfirstlane_b32 s30, v18
    v_readfirstlane_b32 s31, v19
    s_sub_u32 s59, s59, 1
    s_cbranch_scc1 L_qwk
    s_cmp_lt_u32 s31, 4
    s_cbranch_scc1 L_qw
    s_cmp_lt_u32 s30, 1
    s_cbranch_scc1 L_qw
L_qwk:
    s_sub_u32 s58, s30, 1
    .p2align 6
L_layer:
    ds_read_b128 v[16:19], v4 offset:0
    ds_read_b128 v[20:23], v4 offset:64
    ds_read_b128 v[24:27], v4 offset:128
    ds_read_b128 v[28:31], v4 offset:192
    s_waitcnt lgkmcnt(3)
    v_mfma_f32_16x16x32_bf16 v[32:35], v[128:131], v[16:19], 0
    v_mfma_f32_16x16x32_bf16 v[36:39], v[144:147], v[16:19], 0
    v_mfma_f32_16x16x32_bf16 v[40:43], v[160:163], v[16:19], 0
    v_mfma_f32_16x16x32_bf16 v[44:47], v[176:179], v[16:19], 0
    s_waitcnt lgkmcnt(2)
    v_mfma_f32_16x16x32_bf16 v[32:35], v[132:135], v[20:23], v[32:35]
    v_mfma_f32_16x16x32_bf16 v[36:39], v[148:151], v[20:23], v[36:39]
    v_mfma_f32_16x16x32_bf16 v[40:43], v[164:167], v[20:23], v[40:43]
    v_mfma_f32_16x16x32_bf16 v[44:47], v[180:183], v[20:23], v[44:47]
    s_waitcnt lgkmcnt(1)
    v_mfma_f32_16x16x32_bf16 v[32:35], v[136:139], v[24:27], v[32:35]
    v_mfma_f32_16x16x32_bf16 v[36:39], v[152:155], v[24:27], v[36:39]
    v_mfma_f32_16x16x32_bf16 v[40:43], v[168:171], v[24:27], v[40:43]
    v_mfma_f32_16x16x32_bf16 v[44:47], v[184:187], v[24:27], v[44:47]
    s_waitcnt lgkmcnt(0)
    v_mfma_f32_16x16x32_bf16 v[32:35], v[140:143], v[28:31], v[32:35]
    v_mfma_f32_16x16x32_bf16 v[36:39], v[156:159], v[28:31], v[36:39]
    v_mfma_f32_16x16x32_bf16 v[40:43], v[172:175], v[28:31], v[40:43]
    v_mfma_f32_16x16x32_bf16 v[44:47], v[188:191], v[28:31], v[44:47]
    s_nop 5
    v_mov_b32_dpp v32, v36 quad_perm:[0,1,2,3] row_mask:0xf bank_mask:2
    v_mov_b32_dpp v33, v37 quad_perm:[0,1,2,3] row_mask:0xf bank_mask:2
    v_mov_b32_dpp v34, v38 quad_perm:[0,1,2,3] row_mask:0xf bank_mask:2
    v_mov_b32_dpp v35, v39 quad_perm:[0,1,2,3] row_mask:0xf bank_mask:2
    v_mov_b32_dpp v32, v40 quad_perm:[0,1,2,3] row_mask:0xf bank_mask:4
    v_mov_b32_dpp v33, v41 quad_perm:[0,1,2,3] row_mask:0xf bank_mask:4
    v_mov_b32_dpp v34, v42 quad_perm:[0,1,2,3] row_mask:0xf bank_mask:4
    v_mov_b32_dpp v35, v43 quad_perm:[0,1,2,3] row_mask:0xf bank_mask:4
    v_mov_b32_dpp v32, v44 quad_perm:[0,1,2,3] row_mask:0xf bank_mask:8
    v_mov_b32_dpp v33, v45 quad_perm:[0,1,2,3] row_mask:0xf bank_mask:8
    v_mov_b32_dpp v34, v46 quad_perm:[0,1,2,3] row_mask:0xf bank_mask:8
    v_mov_b32_dpp v35, v47 quad_perm:[0,1,2,3] row_mask:0xf bank_mask:8
    v_max3_f32 v36, v32, v33, v34
    v_max_f32 v36, v36, v35
    s_nop 1
    v_max_f32_dpp v36, v36, v36 row_ror:4 row_mask:0xf bank_mask:0xf
    s_nop 1
    v_max_f32_dpp v36, v36, v36 row_ror:8 row_mask:0xf bank_mask:0xf
    v_mov_b32 v37, v36
    s_nop 1
    v_permlane16_swap_b32 v36, v37
    v_max_f32 v36, v36, v37
    v_mov_b32 v37, v36
    s_nop 1
    v_permlane32_swap_b32 v36, v37
    v_max_f32 v36, v36, v37
    v_mul_f32 v62, v55, v36
    v_fma_f32 v32, v32, v55, -v62
    v_fma_f32 v33, v33, v55, -v62
    v_fma_f32 v34, v34, v55, -v62
    v_fma_f32 v35, v35, v55, -v62
    v_exp_f32 v32, v32
    v_exp_f32 v33, v33
    v_exp_f32 v34, v34
    v_exp_f32 v35, v35
    v_cvt_pk_bf16_f32 v48, v32, v33
    v_cvt_pk_bf16_f32 v49, v34, v35
    ds_write_b32 v5, v62 offset:512
    v_and_b32 v16, v48, v50
    v_and_b32 v17, v49, v50
    v_and_b32_dpp v18, v48, v50 row_shl:4 row_mask:0xf bank_mask:0xf bound_ctrl:0
    v_and_b32_dpp v19, v49, v50 row_shl:4 row_mask:0xf bank_mask:0xf bound_ctrl:0
    v_and_b32_dpp v20, v48, v50 row_shl:8 row_mask:0xf bank_mask:0xf bound_ctrl:0
    v_and_b32_dpp v21, v49, v50 row_shl:8 row_mask:0xf bank_mask:0xf bound_ctrl:0
    v_and_b32_dpp v22, v48, v50 row_shl:12 row_mask:0xf bank_mask:0xf bound_ctrl:0
    v_and_b32_dpp v23, v49, v50 row_shl:12 row_mask:0xf bank_mask:0xf bound_ctrl:0
    s_cmp_lg_u32 s60, 0
    s_cbranch_scc1 L_pv2
    s_mov_b32 s60, 1
    s_waitcnt vmcnt(8)
    ds_write_b128 v60, v[192:195] offset:0
    ds_write_b128 v60, v[196:199] offset:1152
    ds_write_b128 v60, v[200:203] offset:2304
    ds_write_b128 v60, v[204:207] offset:3456
    ds_write_b128 v60, v[208:211] offset:4608
    ds_write_b128 v60, v[212:215] offset:5760
    ds_write_b128 v60, v[216:219] offset:6912
    ds_write_b128 v60, v[220:223] offset:8064
    ds_read_b64_tr_b16 v[192:193], v61 offset:0
    ds_read_b64_tr_b16 v[194:195], v61 offset:4608
    ds_read_b64_tr_b16 v[196:197], v61 offset:32
    ds_read_b64_tr_b16 v[198:199], v61 offset:4640
    ds_read_b64_tr_b16 v[200:201], v61 offset:64
    ds_read_b64_tr_b16 v[202:203], v61 offset:4672
    ds_read_b64_tr_b16 v[204:205], v61 offset:96
    ds_read_b64_tr_b16 v[206:207], v61 offset:4704
    ds_read_b64_tr_b16 v[208:209], v61 offset:128
    ds_read_b64_tr_b16 v[210:211], v61 offset:4736
    ds_read_b64_tr_b16 v[212:213], v61 offset:160
    ds_read_b64_tr_b16 v[214:215], v61 offset:4768
    ds_read_b64_tr_b16 v[216:217], v61 offset:192
    ds_read_b64_tr_b16 v[218:219], v61 offset:4800
    ds_read_b64_tr_b16 v[220:221], v61 offset:224
    ds_read_b64_tr_b16 v[222:223], v61 offset:4832
    s_waitcnt vmcnt(0)
    ds_write_b128 v60, v[224:227] offset:0
    ds_write_b128 v60, v[228:231] offset:1152
    ds_write_b128 v60, v[232:235] offset:2304
    ds_write_b128 v60, v[236:239] offset:3456
    ds_write_b128 v60, v[240:243] offset:4608
    ds_write_b128 v60, v[244:247] offset:5760
    ds_write_b128 v60, v[248:251] offset:6912
    ds_write_b128 v60, v[252:255] offset:8064
    ds_read_b64_tr_b16 v[224:225], v61 offset:0
    ds_read_b64_tr_b16 v[226:227], v61 offset:4608
    ds_read_b64_tr_b16 v[228:229], v61 offset:32
    ds_read_b64_tr_b16 v[230:231], v61 offset:4640
    ds_read_b64_tr_b16 v[232:233], v61 offset:64
    ds_read_b64_tr_b16 v[234:235], v61 offset:4672
    ds_read_b64_tr_b16 v[236:237], v61 offset:96
    ds_read_b64_tr_b16 v[238:239], v61 offset:4704
    ds_read_b64_tr_b16 v[240:241], v61 offset:128
    ds_read_b64_tr_b16 v[242:243], v61 offset:4736
    ds_read_b64_tr_b16 v[244:245], v61 offset:160
    ds_read_b64_tr_b16 v[246:247], v61 offset:4768
    ds_read_b64_tr_b16 v[248:249], v61 offset:192
    ds_read_b64_tr_b16 v[250:251], v61 offset:4800
    ds_read_b64_tr_b16 v[252:253], v61 offset:224
    ds_read_b64_tr_b16 v[254:255], v61 offset:4832
    s_waitcnt lgkmcnt(0)
L_pv2:
    v_mfma_f32_16x16x32_bf16 v[32:35], v[192:195], v[16:19], 0
    v_and_b32_dpp v24, v48, v51 row_shr:4 row_mask:0xf bank_mask:0xf bound_ctrl:0
    v_and_b32_dpp v25, v49, v51 row_shr:4 row_mask:0xf bank_mask:0xf bound_ctrl:0
    v_mfma_f32_16x16x32_bf16 v[36:39], v[200:203], v[16:19], 0
    v_and_b32 v26, v48, v51
    v_and_b32 v27, v49, v51
    v_mfma_f32_16x16x32_bf16 v[60:63], v[56:59], v[16:19], 0
    v_mfma_f32_16x16x32_bf16 v[32:35], v[224:227], v[20:23], v[32:35]
    v_and_b32_dpp v28, v48, v51 row_shl:4 row_mask:0xf bank_mask:0xf bound_ctrl:0
    v_and_b32_dpp v29, v49, v51 row_shl:4 row_mask:0xf bank_mask:0xf bound_ctrl:0
    v_mfma_f32_16x16x32_bf16 v[36:39], v[232:235], v[20:23], v[36:39]
    v_and_b32_dpp v30, v48, v51 row_shl:8 row_mask:0xf bank_mask:0xf bound_ctrl:0
    v_and_b32_dpp v31, v49, v51 row_shl:8 row_mask:0xf bank_mask:0xf bound_ctrl:0
    v_mfma_f32_16x16x32_bf16 v[60:63], v[56:59], v[20:23], v[60:63]
    v_mfma_f32_16x16x32_bf16 v[32:35], v[196:199], v[24:27], v[32:35]
    v_mfma_f32_16x16x32_bf16 v[36:39], v[204:207], v[24:27], v[36:39]
    v_mfma_f32_16x16x32_bf16 v[32:35], v[228:231], v[28:31], v[32:35]
    s_mov_b32 exec_lo, 0x000f000f
    s_mov_b32 exec_hi, 0x000f000f
    v_mfma_f32_16x16x32_bf16 v[36:39], v[236:239], v[28:31], v[36:39]
    s_nop 1
    ds_write_b32 v5, v60 offset:516
    v_mfma_f32_16x16x32_bf16 v[40:43], v[208:211], v[16:19], 0
    s_mov_b32 exec_lo, 0x00ff00ff
    s_mov_b32 exec_hi, 0x00ff00ff
    v_mfma_f32_16x16x32_bf16 v[44:47], v[216:219], v[16:19], 0
    ds_write_b128 v54, v[32:35]
    v_mfma_f32_16x16x32_bf16 v[40:43], v[240:243], v[20:23], v[40:43]
    ds_write_b128 v54, v[36:39] offset:128
    v_mfma_f32_16x16x32_bf16 v[44:47], v[248:251], v[20:23], v[44:47]
    v_mfma_f32_16x16x32_bf16 v[40:43], v[212:215], v[24:27], v[40:43]
    v_mfma_f32_16x16x32_bf16 v[44:47], v[220:223], v[24:27], v[44:47]
    v_mfma_f32_16x16x32_bf16 v[40:43], v[244:247], v[28:31], v[40:43]
    v_mfma_f32_16x16x32_bf16 v[44:47], v[252:255], v[28:31], v[44:47]
    s_nop 6
    ds_write_b128 v54, v[40:43] offset:256
    ds_write_b128 v54, v[44:47] offset:384
    s_mov_b64 exec, -1
    s_cmp_lt_u32 s3, 4
    s_cbranch_scc0 L_hi
    s_cmp_lg_u32 s57, 0
    s_cbranch_scc1 L_lo2
    s_cmp_lg_u32 s3, 1
    s_cbranch_scc1 L_nck
    s_mov_b32 s59, 262144
L_fa:
    s_waitcnt vmcnt(0)
    v_xor_b32 v112, s100, v112
    v_xor_b32 v113, s101, v113
    v_xor_b32 v114, s100, v114
    v_xor_b32 v115, s101, v115
    v_xor_b32 v116, s100, v116
    v_xor_b32 v117, s101, v117
    v_xor_b32 v118, s100, v118
    v_xor_b32 v119, s101, v119
    v_or3_b32 v112, v112, v114, v116
    v_or_b32 v112, v112, v118
    v_lshrrev_b32 v114, 4, v112
    v_or3_b32 v114, v114, v113, v115
    v_or3_b32 v114, v114, v117, v119
    v_cmp_ne_u32 vcc, 0, v114
    s_sub_u32 s59, s59, 1
    s_cbranch_scc1 L_fak
    s_cbranch_vccz L_fak
    v_lshrrev_b32 v120, 1, v0
    v_lshlrev_b32 v120, 6, v120
    v_lshl_add_u32 v120, v0, 5, v120
    s_mov_b32 s61, 1507328
    buffer_load_dwordx4 v[112:115], v120, s[48:51], s61 offen sc1
    buffer_load_dwordx4 v[116:119], v120, s[48:51], s61 offen offset:16 sc1
    s_branch L_fa
L_fak:
L_nck:
    v_mov_b32 v16, 163584
    s_mov_b32 s59, 262144
L_iw:
    s_nop 15
    ds_read_b32 v17, v16 offset:12
    s_waitcnt lgkmcnt(0)
    v_readfirstlane_b32 s30, v17
    s_sub_u32 s59, s59, 1
    s_cbranch_scc1 L_iwk
    s_cmp_lt_u32 s30, 4
    s_cbranch_scc1 L_iw
L_iwk:
    s_lshl_b32 s30, s53, 19
    s_lshl_b32 s31, s3, 17
    s_add_u32 s30, s30, s31
    s_lshl_b32 s31, s54, 7
    s_add_u32 s30, s30, s31
    s_lshl_b32 s31, s3, 14
    v_lshrrev_b32 v48, 3, v0
    v_lshlrev_b32 v48, 10, v48
    v_bfe_u32 v49, v0, 4, 1
    v_lshlrev_b32 v49, 1, v49
    v_and_b32 v50, 7, v0
    v_xor_b32 v49, v49, v50
    v_lshl_add_u32 v48, v49, 4, v48
    v_xor_b32 v49, 64, v48
    s_mov_b32 m0, s31
    s_add_u32 s31, s31, 1024
    buffer_load_dwordx4 v48, s[44:47], s30 offen nt lds
    s_add_u32 s30, s30, 8192
    s_mov_b32 m0, s31
    s_add_u32 s31, s31, 1024
    buffer_load_dwordx4 v49, s[44:47], s30 offen nt lds
    s_add_u32 s30, s30, 8192
    s_mov_b32 m0, s31
    s_add_u32 s31, s31, 1024
    buffer_load_dwordx4 v48, s[44:47], s30 offen nt lds
    s_add_u32 s30, s30, 8192
    s_mov_b32 m0, s31
    s_add_u32 s31, s31, 1024
    buffer_load_dwordx4 v49, s[44:47], s30 offen nt lds
    s_add_u32 s30, s30, 8192
    s_mov_b32 m0, s31
    s_add_u32 s31, s31, 1024
    buffer_load_dwordx4 v48, s[44:47], s30 offen nt lds
    s_add_u32 s30, s30, 8192
    s_mov_b32 m0, s31
    s_add_u32 s31, s31, 1024
    buffer_load_dwordx4 v49, s[44:47], s30 offen nt lds
    s_add_u32 s30, s30, 8192
    s_mov_b32 m0, s31
    s_add_u32 s31, s31, 1024
    buffer_load_dwordx4 v48, s[44:47], s30 offen nt lds
    s_add_u32 s30, s30, 8192
    s_mov_b32 m0, s31
    s_add_u32 s31, s31, 1024
    buffer_load_dwordx4 v49, s[44:47], s30 offen nt lds
    s_add_u32 s30, s30, 8192
    s_mov_b32 m0, s31
    s_add_u32 s31, s31, 1024
    buffer_load_dwordx4 v48, s[44:47], s30 offen nt lds
    s_add_u32 s30, s30, 8192
    s_mov_b32 m0, s31
    s_add_u32 s31, s31, 1024
    buffer_load_dwordx4 v49, s[44:47], s30 offen nt lds
    s_add_u32 s30, s30, 8192
    s_mov_b32 m0, s31
    s_add_u32 s31, s31, 1024
    buffer_load_dwordx4 v48, s[44:47], s30 offen nt lds
    s_add_u32 s30, s30, 8192
    s_mov_b32 m0, s31
    s_add_u32 s31, s31, 1024
    buffer_load_dwordx4 v49, s[44:47], s30 offen nt lds
    s_add_u32 s30, s30, 8192
    s_mov_b32 m0, s31
    s_add_u32 s31, s31, 1024
    buffer_load_dwordx4 v48, s[44:47], s30 offen nt lds
    s_add_u32 s30, s30, 8192
    s_mov_b32 m0, s31
    s_add_u32 s31, s31, 1024
    buffer_load_dwordx4 v49, s[44:47], s30 offen nt lds
    s_add_u32 s30, s30, 8192
    s_mov_b32 m0, s31
    s_add_u32 s31, s31, 1024
    buffer_load_dwordx4 v48, s[44:47], s30 offen nt lds
    s_add_u32 s30, s30, 8192
    s_mov_b32 m0, s31
    s_add_u32 s31, s31, 1024
    buffer_load_dwordx4 v49, s[44:47], s30 offen nt lds
    s_add_u32 s30, s30, 8192
    s_waitcnt lgkmcnt(0)
    s_barrier
    s_cmp_lg_u32 s3, 2
    s_cbranch_scc1 L_notp
    v_lshlrev_b32 v24, 2, v0
    v_add_u32 v24, 162816, v24
    ds_read_b32 v16, v24 offset:0
    ds_read_b32 v17, v24 offset:96
    ds_read_b32 v18, v24 offset:192
    ds_read_b32 v19, v24 offset:288
    ds_read_b32 v20, v24 offset:384
    ds_read_b32 v21, v24 offset:480
    ds_read_b32 v22, v24 offset:576
    s_waitcnt lgkmcnt(0)
    v_add_f32 v16, v16, v17
    v_add_f32 v16, v16, v18
    v_add_f32 v16, v16, v19
    v_add_f32 v16, v16, v20
    v_add_f32 v16, v16, v21
    v_add_f32 v16, v16, v22
    s_nop 1
    v_mov_b32_dpp v17, v16 quad_perm:[2,3,2,3] row_mask:0xf bank_mask:0xf
    v_cvt_pk_bf16_f32 v16, v16, v17
    v_min_u32 v16, 0xfffffffe, v16
    v_and_b32 v24, 1, v0
    v_mul_u32_u24 v24, 6144, v24
    v_and_b32 v25, 0x3c, v0
    v_add_u32 v24, v24, v25
    s_mul_i32 s30, s55, 24
    s_add_u32 s30, s30, 1490944
    s_mov_b32 exec_lo, 0x00333333
    s_mov_b32 exec_hi, 0
    buffer_store_dword v16, v24, s[48:51], s30 offen sc1
    s_mov_b64 exec, -1
    s_waitcnt vmcnt(1)
    s_branch L_notp2
L_notp:
    s_waitcnt vmcnt(0)
L_notp2:
    v_mov_b32 v16, 163584
    v_mov_b32 v17, 1
    s_mov_b64 exec, 1
    ds_add_u32 v16, v17
    s_mov_b64 exec, -1
    s_mov_b32 s59, 262144
L_wos:
    ds_read_b32 v17, v16
    s_waitcnt lgkmcnt(0)
    v_readfirstlane_b32 s30, v17
    s_sub_u32 s59, s59, 1
    s_cbranch_scc1 L_wok
    s_cmp_lt_u32 s30, 4
    s_cbranch_scc1 L_wos
L_wok:
    ds_read_b64_tr_b16 v[64:65], v7 offset:0
    ds_read_b64_tr_b16 v[66:67], v7 offset:512
    ds_read_b64_tr_b16 v[68:69], v7 offset:4096
    ds_read_b64_tr_b16 v[70:71], v7 offset:4608
    ds_read_b64_tr_b16 v[72:73], v7 offset:8192
    ds_read_b64_tr_b16 v[74:75], v7 offset:8704
    ds_read_b64_tr_b16 v[76:77], v7 offset:12288
    ds_read_b64_tr_b16 v[78:79], v7 offset:12800
    ds_read_b64_tr_b16 v[80:81], v7 offset:16384
    ds_read_b64_tr_b16 v[82:83], v7 offset:16896
    ds_read_b64_tr_b16 v[84:85], v7 offset:20480
    ds_read_b64_tr_b16 v[86:87], v7 offset:20992
    ds_read_b64_tr_b16 v[88:89], v7 offset:24576
    ds_read_b64_tr_b16 v[90:91], v7 offset:25088
    ds_read_b64_tr_b16 v[92:93], v7 offset:28672
    ds_read_b64_tr_b16 v[94:95], v7 offset:29184
    ds_read_b64_tr_b16 v[96:97], v7 offset:32768
    ds_read_b64_tr_b16 v[98:99], v7 offset:33280
    ds_read_b64_tr_b16 v[100:101], v7 offset:36864
    ds_read_b64_tr_b16 v[102:103], v7 offset:37376
    ds_read_b64_tr_b16 v[104:105], v7 offset:40960
    ds_read_b64_tr_b16 v[106:107], v7 offset:41472
    ds_read_b64_tr_b16 v[108:109], v7 offset:45056
    ds_read_b64_tr_b16 v[110:111], v7 offset:45568
    ds_read_b64_tr_b16 v[112:113], v7 offset:49152
    ds_read_b64_tr_b16 v[114:115], v7 offset:49664
    ds_read_b64_tr_b16 v[116:117], v7 offset:53248
    ds_read_b64_tr_b16 v[118:119], v7 offset:53760
    ds_read_b64_tr_b16 v[120:121], v7 offset:57344
    ds_read_b64_tr_b16 v[122:123], v7 offset:57856
    ds_read_b64_tr_b16 v[124:125], v7 offset:61440
    ds_read_b64_tr_b16 v[126:127], v7 offset:61952
    s_branch L_lo3
L_lo2:
    s_waitcnt lgkmcnt(0)
    s_barrier
L_lo3:
    s_lshl_b32 s92, s57, 16
    s_lshl_b32 s31, s55, 8
    s_add_u32 s92, s92, s31
    s_lshl_b32 s31, s3, 6
    s_add_u32 s92, s92, s31
    s_add_u32 s92, s92, 1327104
    v_lshlrev_b32 v56, 4, v2
    s_waitcnt lgkmcnt(0)
    s_barrier
    ds_read_b128 v[24:27], v6 offset:0
    ds_read_b128 v[28:31], v6 offset:128
    ds_read_b128 v[32:35], v6 offset:256
    ds_read_b128 v[36:39], v6 offset:384
    ds_read_b128 v[40:43], v6 offset:512
    ds_read_b128 v[44:47], v6 offset:640
    ds_read_b128 v[48:51], v6 offset:768
    ds_read_b128 v[52:55], v6 offset:896
    s_waitcnt lgkmcnt(7)
    v_mfma_f32_16x16x32_bf16 v[16:19], v[64:67], v[24:27], 0
    v_mfma_f32_16x16x32_bf16 v[20:23], v[68:71], v[24:27], 0
    s_waitcnt lgkmcnt(6)
    v_mfma_f32_16x16x32_bf16 v[16:19], v[72:75], v[28:31], v[16:19]
    v_mfma_f32_16x16x32_bf16 v[20:23], v[76:79], v[28:31], v[20:23]
    s_waitcnt lgkmcnt(5)
    v_mfma_f32_16x16x32_bf16 v[16:19], v[80:83], v[32:35], v[16:19]
    v_mfma_f32_16x16x32_bf16 v[20:23], v[84:87], v[32:35], v[20:23]
    s_waitcnt lgkmcnt(4)
    v_mfma_f32_16x16x32_bf16 v[16:19], v[88:91], v[36:39], v[16:19]
    v_mfma_f32_16x16x32_bf16 v[20:23], v[92:95], v[36:39], v[20:23]
    s_waitcnt lgkmcnt(3)
    v_mfma_f32_16x16x32_bf16 v[16:19], v[96:99], v[40:43], v[16:19]
    v_mfma_f32_16x16x32_bf16 v[20:23], v[100:103], v[40:43], v[20:23]
    s_waitcnt lgkmcnt(2)
    v_mfma_f32_16x16x32_bf16 v[16:19], v[104:107], v[44:47], v[16:19]
    v_mfma_f32_16x16x32_bf16 v[20:23], v[108:111], v[44:47], v[20:23]
    s_waitcnt lgkmcnt(1)
    v_mfma_f32_16x16x32_bf16 v[16:19], v[112:115], v[48:51], v[16:19]
    s_mov_b32 vcc_lo, 0x00010001
    s_mov_b32 vcc_hi, 0x00010001
    v_mfma_f32_16x16x32_bf16 v[20:23], v[116:119], v[48:51], v[20:23]
    s_waitcnt lgkmcnt(0)
    v_mfma_f32_16x16x32_bf16 v[16:19], v[120:123], v[52:55], v[16:19]
    v_mfma_f32_16x16x32_bf16 v[20:23], v[124:127], v[52:55], v[20:23]
    s_nop 7
    v_add_f32_dpp v16, v20, v16 row_shl:1 row_mask:0xf bank_mask:0xf
    v_add_f32_dpp v17, v21, v17 row_shl:1 row_mask:0xf bank_mask:0xf
    v_add_f32_dpp v18, v22, v18 row_shl:1 row_mask:0xf bank_mask:0xf
    v_add_f32_dpp v19, v23, v19 row_shl:1 row_mask:0xf bank_mask:0xf
    s_mov_b64 exec, vcc
    v_min_u32 v16, 0xfffffffe, v16
    v_min_u32 v17, 0xfffffffe, v17
    v_min_u32 v18, 0xfffffffe, v18
    v_min_u32 v19, 0xfffffffe, v19
    buffer_store_dwordx4 v[16:19], v56, s[48:51], s92 offen sc1
    s_mov_b64 exec, -1
    s_cmp_lg_u32 s57, 0
    s_cbranch_scc1 L_fin
    s_mul_i32 s30, s3, 3072
    s_add_u32 s31, s30, 1490944
    s_mov_b32 s59, 262144
L_tg:
    buffer_load_dwordx4 v[16:19], v1, s[48:51], s31 offen offset:0 sc1
    buffer_load_dwordx4 v[20:23], v1, s[48:51], s31 offen offset:1024 sc1
    buffer_load_dwordx4 v[24:27], v1, s[48:51], s31 offen offset:2048 sc1
    s_waitcnt vmcnt(0)
    v_max3_u32 v28, v16, v17, v18
    v_max3_u32 v28, v28, v19, v20
    v_max3_u32 v28, v28, v21, v22
    v_max3_u32 v28, v28, v23, v24
    v_max3_u32 v28, v28, v25, v26
    v_max_u32 v28, v28, v27
    v_cmp_eq_u32 vcc, -1, v28
    s_sub_u32 s59, s59, 1
    s_cbranch_scc1 L_tgok
    s_cbranch_vccnz L_tg
L_tgok:
    s_add_u32 s31, s30, 65536
    s_add_u32 s30, s30, 124928
    s_cmp_lt_u32 s3, 2
    s_cselect_b32 s30, s31, s30
    v_add_u32 v28, s30, v1
    ds_write_b128 v28, v[16:19] offset:0
    ds_write_b128 v28, v[20:23] offset:1024
    ds_write_b128 v28, v[24:27] offset:2048
    s_waitcnt lgkmcnt(0)
    s_barrier
    v_mov_b32 v56, 0x3f803f80
    v_mov_b32 v57, 0x3f803f80
    v_mov_b32 v58, 0x3f803f80
    v_mov_b32 v59, 0x3f803f80
    v_lshrrev_b32 v54, 2, v3
    v_lshlrev_b32 v55, v54, 1
    v_lshl_add_u32 v54, v54, 6, v5
    v_bfe_i32 v50, v55, 0, 1
    v_bfe_i32 v51, v55, 1, 1
    v_bfe_i32 v52, v55, 2, 1
    v_bfe_i32 v53, v55, 3, 1
    v_mov_b32 v55, 0x3e0293ee
    s_cmp_lg_u32 s3, 0
    s_cbranch_scc1 L_B5
    s_lshl_b32 s30, s56, 10
    s_add_u32 s30, s30, 1458176
    v_lshl_add_u32 v20, v2, 6, v1
    v_add_u32 v20, 158464, v20
    s_mov_b32 s59, 262144
L_x4:
    buffer_load_dwordx4 v[16:19], v1, s[48:51], s30 offen sc1
    s_waitcnt vmcnt(0)
    ds_write_b128 v20, v[16:19]
    v_max3_u32 v21, v16, v17, v18
    v_max_u32 v21, v21, v19
    v_cmp_eq_u32 vcc, -1, v21
    s_sub_u32 s59, s59, 1
    s_cbranch_scc1 L_x4ok
    s_cbranch_vccnz L_x4
L_x4ok:
L_B5:
    s_mov_b32 s57, 1
    s_waitcnt lgkmcnt(0)
    s_barrier
    s_branch L_layer
L_hi:
    s_waitcnt lgkmcnt(0)
    s_barrier
    ds_read_b64 v[16:17], v120 offset:512
    ds_read_b64 v[18:19], v120 offset:2880
    ds_read_b64 v[20:21], v120 offset:5248
    ds_read_b64 v[22:23], v120 offset:7616
    ds_read_b64 v[24:25], v120 offset:9984
    ds_read_b64 v[26:27], v120 offset:12352
    ds_read_b64 v[28:29], v120 offset:14720
    ds_read_b64 v[30:31], v120 offset:17088
    ds_read_b64 v[32:33], v121 offset:0
    ds_read_b64 v[34:35], v121 offset:2368
    ds_read_b64 v[36:37], v121 offset:4736
    ds_read_b64 v[38:39], v121 offset:7104
    ds_read_b64 v[40:41], v121 offset:9472
    ds_read_b64 v[42:43], v121 offset:11840
    ds_read_b64 v[44:45], v121 offset:14208
    ds_read_b64 v[46:47], v121 offset:16576
    s_waitcnt lgkmcnt(8)
    v_max3_f32 v52, v16, v18, v20
    v_max3_f32 v53, v22, v24, v26
    v_max3_f32 v52, v52, v28, v30
    v_max_f32 v52, v52, v53
    v_sub_f32 v16, v16, v52
    v_sub_f32 v18, v18, v52
    v_sub_f32 v20, v20, v52
    v_sub_f32 v22, v22, v52
    v_sub_f32 v24, v24, v52
    v_sub_f32 v26, v26, v52
    v_sub_f32 v28, v28, v52
    v_sub_f32 v30, v30, v52
    v_exp_f32 v16, v16
    v_exp_f32 v18, v18
    v_exp_f32 v20, v20
    v_exp_f32 v22, v22
    v_exp_f32 v24, v24
    v_exp_f32 v26, v26
    v_exp_f32 v28, v28
    v_exp_f32 v30, v30
    s_waitcnt lgkmcnt(0)
    v_mul_f32 v53, v16, v17
    v_pk_mul_f32 v[54:55], v[32:33], v[16:17] op_sel_hi:[1,0]
    v_pk_fma_f32 v[54:55], v[34:35], v[18:19], v[54:55] op_sel_hi:[1,0,1]
    v_fmac_f32 v53, v18, v19
    v_pk_fma_f32 v[54:55], v[36:37], v[20:21], v[54:55] op_sel_hi:[1,0,1]
    v_fmac_f32 v53, v20, v21
    v_pk_fma_f32 v[54:55], v[38:39], v[22:23], v[54:55] op_sel_hi:[1,0,1]
    v_fmac_f32 v53, v22, v23
    v_pk_fma_f32 v[54:55], v[40:41], v[24:25], v[54:55] op_sel_hi:[1,0,1]
    v_fmac_f32 v53, v24, v25
    v_pk_fma_f32 v[54:55], v[42:43], v[26:27], v[54:55] op_sel_hi:[1,0,1]
    v_fmac_f32 v53, v26, v27
    v_pk_fma_f32 v[54:55], v[44:45], v[28:29], v[54:55] op_sel_hi:[1,0,1]
    v_fmac_f32 v53, v28, v29
    v_pk_fma_f32 v[54:55], v[46:47], v[30:31], v[54:55] op_sel_hi:[1,0,1]
    v_fmac_f32 v53, v30, v31
    v_min_u32 v52, 0xfffffffe, v52
    v_min_u32 v53, 0xfffffffe, v53
    v_min_u32 v54, 0xfffffffe, v54
    v_min_u32 v55, 0xfffffffe, v55
    s_cmp_eq_u32 s58, 1
    s_cbranch_scc1 L_2
    buffer_store_dwordx2 v[54:55], v122, s[48:51], s92 offen sc1
    s_mov_b64 exec, 1
    buffer_store_dwordx2 v[52:53], v122, s[48:51], s93 offen sc1
    s_mov_b64 exec, -1
    s_branch L_3
L_2:
    buffer_store_dwordx2 v[54:55], v122, s[48:51], s92 offen
    s_mov_b64 exec, 1
    buffer_store_dwordx2 v[52:53], v122, s[48:51], s93 offen
    s_mov_b64 exec, -1
L_3:
    s_mov_b32 s59, 262144
L_x1:
    buffer_load_dwordx2 v[16:17], v123, s[48:51], s99 offen sc1
    buffer_load_dwordx2 v[32:33], v122, s[48:51], s97 offen offset:0 sc1
    buffer_load_dwordx2 v[34:35], v122, s[48:51], s97 offen offset:2048 sc1
    buffer_load_dwordx2 v[36:37], v122, s[48:51], s98 offen offset:0 sc1
    buffer_load_dwordx2 v[38:39], v122, s[48:51], s98 offen offset:2048 sc1
    buffer_load_dwordx2 v[40:41], v122, s[48:51], s94 offen offset:0 sc1
    buffer_load_dwordx2 v[42:43], v122, s[48:51], s94 offen offset:2048 sc1
    buffer_load_dwordx2 v[44:45], v122, s[48:51], s95 offen offset:0 sc1
    buffer_load_dwordx2 v[46:47], v122, s[48:51], s95 offen offset:2048 sc1
    s_waitcnt vmcnt(8)
    v_max_f32_dpp v19, v16, v16 quad_perm:[1,0,3,2] row_mask:0xf bank_mask:0xf
    s_nop 1
    v_max_f32_dpp v19, v19, v19 quad_perm:[2,3,0,1] row_mask:0xf bank_mask:0xf
    s_nop 1
    v_max_f32_dpp v19, v19, v19 row_half_mirror row_mask:0xf bank_mask:0xf
    v_sub_f32 v18, v16, v19
    v_exp_f32 v18, v18
    s_nop 0
    v_mul_f32 v24, v18, v17
    v_readlane_b32 s84, v18, 0
    v_readlane_b32 s85, v18, 1
    v_add_f32_dpp v24, v24, v24 quad_perm:[1,0,3,2] row_mask:0xf bank_mask:0xf
    v_readlane_b32 s86, v18, 2
    v_readlane_b32 s87, v18, 3
    v_add_f32_dpp v24, v24, v24 quad_perm:[2,3,0,1] row_mask:0xf bank_mask:0xf
    v_readlane_b32 s88, v18, 4
    v_readlane_b32 s89, v18, 5
    v_add_f32_dpp v24, v24, v24 row_half_mirror row_mask:0xf bank_mask:0xf
    v_readlane_b32 s90, v18, 6
    v_readlane_b32 s91, v18, 7
    v_rcp_f32 v24, v24
    s_waitcnt vmcnt(0)
    v_pk_mul_f32 v[20:21], v[32:33], s[84:85] op_sel_hi:[1,0]
    v_pk_fma_f32 v[20:21], v[34:35], s[84:85], v[20:21] op_sel:[0,1,0] op_sel_hi:[1,1,1]
    v_pk_fma_f32 v[20:21], v[36:37], s[86:87], v[20:21] op_sel:[0,0,0] op_sel_hi:[1,0,1]
    v_pk_fma_f32 v[20:21], v[38:39], s[86:87], v[20:21] op_sel:[0,1,0] op_sel_hi:[1,1,1]
    v_pk_fma_f32 v[20:21], v[40:41], s[88:89], v[20:21] op_sel:[0,0,0] op_sel_hi:[1,0,1]
    v_pk_fma_f32 v[20:21], v[42:43], s[88:89], v[20:21] op_sel:[0,1,0] op_sel_hi:[1,1,1]
    v_pk_fma_f32 v[20:21], v[44:45], s[90:91], v[20:21] op_sel:[0,0,0] op_sel_hi:[1,0,1]
    v_pk_fma_f32 v[20:21], v[46:47], s[90:91], v[20:21] op_sel:[0,1,0] op_sel_hi:[1,1,1]
    v_pk_mul_f32 v[20:21], v[20:21], v[24:25] op_sel_hi:[1,0]
    v_cvt_pk_bf16_f32 v23, v20, v21
    ds_write_b32 v124, v23
    v_cmp_u_f32 vcc, v20, v21
    s_cbranch_vccz L_x1ok
    v_max3_u32 v22, v16, v17, v32
    v_max3_u32 v22, v22, v33, v34
    v_max3_u32 v22, v22, v35, v36
    v_max3_u32 v22, v22, v37, v38
    v_max3_u32 v22, v22, v39, v40
    v_max3_u32 v22, v22, v41, v42
    v_max3_u32 v22, v22, v43, v44
    v_max3_u32 v22, v22, v45, v46
    v_max_u32 v22, v22, v47
    v_cmp_eq_u32 vcc, -1, v22
    s_sub_u32 s59, s59, 1
    s_cbranch_scc1 L_x1ok
    s_cbranch_vccz L_x1ok
    s_branch L_x1
L_x1ok:
    s_waitcnt lgkmcnt(0)
    s_barrier
    s_cmp_eq_u32 s57, 0
    s_cbranch_scc1 L_wq
    s_and_b32 s30, s55, 63
    s_cmp_lg_u32 s30, 0
    s_cbranch_scc1 L_fin
    s_branch L_x2i
L_wq:
    s_mul_i32 s31, s96, 96
    s_add_u32 s31, s31, 128
    s_lshl_b32 s30, s52, 7
    s_add_u32 s30, s30, s31
    s_and_b32 s30, s30, 511
    s_lshl_b32 s30, s30, 3
    s_add_u32 s30, s30, s53
    s_lshl3_add_u32 s30, s30, s54
    s_lshl_b32 s30, s30, 7
    s_lshl_b32 s31, s31, 7
    s_add_u32 s31, s31, 0
    v_lshrrev_b32 v20, 3, v0
    v_lshlrev_b32 v20, 13, v20
    v_bfe_u32 v21, v0, 4, 1
    v_lshlrev_b32 v21, 1, v21
    v_and_b32 v22, 7, v0
    v_xor_b32 v21, v21, v22
    v_lshl_add_u32 v20, v21, 4, v20
    v_xor_b32 v21, 64, v20
    s_mov_b32 m0, s31
    s_add_u32 s31, s31, 1024
    buffer_load_dwordx4 v20, s[40:43], s30 offen lds
    s_add_u32 s30, s30, 65536
    s_and_b32 s30, s30, 4194303
    s_mov_b32 m0, s31
    s_add_u32 s31, s31, 1024
    buffer_load_dwordx4 v21, s[40:43], s30 offen lds
    s_add_u32 s30, s30, 65536
    s_and_b32 s30, s30, 4194303
    s_mov_b32 m0, s31
    s_add_u32 s31, s31, 1024
    buffer_load_dwordx4 v20, s[40:43], s30 offen lds
    s_add_u32 s30, s30, 65536
    s_and_b32 s30, s30, 4194303
    s_mov_b32 m0, s31
    s_add_u32 s31, s31, 1024
    buffer_load_dwordx4 v21, s[40:43], s30 offen lds
    s_add_u32 s30, s30, 65536
    s_and_b32 s30, s30, 4194303
    s_mov_b32 m0, s31
    s_add_u32 s31, s31, 1024
    buffer_load_dwordx4 v20, s[40:43], s30 offen lds
    s_add_u32 s30, s30, 65536
    s_and_b32 s30, s30, 4194303
    s_mov_b32 m0, s31
    s_add_u32 s31, s31, 1024
    buffer_load_dwordx4 v21, s[40:43], s30 offen lds
    s_add_u32 s30, s30, 65536
    s_and_b32 s30, s30, 4194303
    s_mov_b32 m0, s31
    s_add_u32 s31, s31, 1024
    buffer_load_dwordx4 v20, s[40:43], s30 offen lds
    s_add_u32 s30, s30, 65536
    s_and_b32 s30, s30, 4194303
    s_mov_b32 m0, s31
    s_add_u32 s31, s31, 1024
    buffer_load_dwordx4 v21, s[40:43], s30 offen lds
    s_add_u32 s30, s30, 65536
    s_and_b32 s30, s30, 4194303
    s_mov_b32 m0, s31
    s_add_u32 s31, s31, 1024
    buffer_load_dwordx4 v20, s[40:43], s30 offen lds
    s_add_u32 s30, s30, 65536
    s_and_b32 s30, s30, 4194303
    s_mov_b32 m0, s31
    s_add_u32 s31, s31, 1024
    buffer_load_dwordx4 v21, s[40:43], s30 offen lds
    s_add_u32 s30, s30, 65536
    s_and_b32 s30, s30, 4194303
    s_mov_b32 m0, s31
    s_add_u32 s31, s31, 1024
    buffer_load_dwordx4 v20, s[40:43], s30 offen lds
    s_add_u32 s30, s30, 65536
    s_and_b32 s30, s30, 4194303
    s_mov_b32 m0, s31
    s_add_u32 s31, s31, 1024
    buffer_load_dwordx4 v21, s[40:43], s30 offen lds
    s_add_u32 s30, s30, 65536
    s_and_b32 s30, s30, 4194303
L_x2i:
    s_lshl_b32 s97, s57, 16
    s_lshl_b32 s31, s52, 14
    s_add_u32 s97, s97, s31
    s_lshl_b32 s31, s96, 9
    s_add_u32 s97, s97, s31
    s_add_u32 s97, s97, 1327104
    s_add_u32 s98, s97, 4096
    s_add_u32 s94, s97, 8192
    s_add_u32 s95, s97, 12288
    s_add_u32 s31, s31, 160768
    v_add_u32 v58, s31, v122
    v_lshlrev_b32 v59, 5, v0
    v_add_u32 v59, 160768, v59
    s_lshl_b32 s92, s55, 7
    s_lshl_b32 s31, s96, 5
    s_add_u32 s92, s92, s31
    s_add_u32 s92, s92, 1458176
    v_lshlrev_b32 v60, 3, v2
    s_lshl_b32 s31, s52, 8
    v_subrev_u32 v61, s31, v1
    v_and_b32 v61, 1023, v61
    v_add_u32 v61, 159744, v61
    v_add_u32 v62, 139264, v1
    v_add_u32 v63, 4294946816, v124
    s_mov_b32 s59, 262144
L_x2:
    buffer_load_dwordx2 v[32:33], v122, s[48:51], s97 offen offset:0 sc1
    buffer_load_dwordx2 v[34:35], v122, s[48:51], s97 offen offset:2048 sc1
    buffer_load_dwordx2 v[36:37], v122, s[48:51], s98 offen offset:0 sc1
    buffer_load_dwordx2 v[38:39], v122, s[48:51], s98 offen offset:2048 sc1
    buffer_load_dwordx2 v[40:41], v122, s[48:51], s94 offen offset:0 sc1
    buffer_load_dwordx2 v[42:43], v122, s[48:51], s94 offen offset:2048 sc1
    buffer_load_dwordx2 v[44:45], v122, s[48:51], s95 offen offset:0 sc1
    buffer_load_dwordx2 v[46:47], v122, s[48:51], s95 offen offset:2048 sc1
    s_waitcnt vmcnt(0)
    v_pk_add_f32 v[16:17], v[32:33], v[34:35]
    v_pk_add_f32 v[18:19], v[36:37], v[38:39]
    v_pk_add_f32 v[20:21], v[40:41], v[42:43]
    v_pk_add_f32 v[24:25], v[44:45], v[46:47]
    v_pk_add_f32 v[16:17], v[16:17], v[18:19]
    v_pk_add_f32 v[20:21], v[20:21], v[24:25]
    v_pk_add_f32 v[20:21], v[20:21], v[16:17]
    v_cvt_pk_bf16_f32 v16, v20, v21
    v_lshlrev_b32 v18, 16, v16
    v_and_b32 v19, 0xffff0000, v16
    v_pk_add_f32 v[18:19], v[18:19], v[8:9]
    v_cvt_pk_bf16_f32 v16, v18, v19
    v_lshlrev_b32 v18, 16, v16
    v_and_b32 v19, 0xffff0000, v16
    ds_write_b64 v58, v[18:19]
    v_cmp_u_f32 vcc, v20, v21
    s_cbranch_vccz L_x2ok
    v_max3_u32 v22, v32, v33, v34
    v_max3_u32 v22, v22, v35, v36
    v_max3_u32 v22, v22, v37, v38
    v_max3_u32 v22, v22, v39, v40
    v_max3_u32 v22, v22, v41, v42
    v_max3_u32 v22, v22, v43, v44
    v_max3_u32 v22, v22, v45, v46
    v_max_u32 v22, v22, v47
    v_cmp_eq_u32 vcc, -1, v22
    s_sub_u32 s59, s59, 1
    s_cbranch_scc1 L_x2ok
    s_cbranch_vccz L_x2ok
    s_branch L_x2
L_x2ok:
    s_waitcnt lgkmcnt(0)
    s_barrier
    ds_read_b128 v[8:11], v59
    ds_read_b128 v[12:15], v59 offset:16
    v_mov_b32 v50, 0
    v_mov_b32 v51, 0
    v_mov_b32 v52, 0
    v_mov_b32 v53, 0
    v_mov_b32 v54, 0
    v_mov_b32 v55, 0
    v_mov_b32 v56, 0
    v_mov_b32 v57, 0
    s_cmp_lg_u32 s57, 0
    s_cbranch_scc1 L_out
    s_waitcnt lgkmcnt(0)
    v_readfirstlane_b32 s30, v8
    ds_read_b64_tr_b16 v[80:81], v7 offset:16384
    ds_read_b64_tr_b16 v[82:83], v7 offset:16896
    v_pk_add_f32 v[16:17], v[8:9], s[30:31] op_sel_hi:[1,0] neg_lo:[0,1] neg_hi:[0,1]
    v_pk_add_f32 v[18:19], v[10:11], s[30:31] op_sel_hi:[1,0] neg_lo:[0,1] neg_hi:[0,1]
    v_pk_add_f32 v[20:21], v[12:13], s[30:31] op_sel_hi:[1,0] neg_lo:[0,1] neg_hi:[0,1]
    v_pk_add_f32 v[22:23], v[14:15], s[30:31] op_sel_hi:[1,0] neg_lo:[0,1] neg_hi:[0,1]
    v_pk_add_f32 v[28:29], v[16:17], v[18:19]
    v_pk_mul_f32 v[30:31], v[16:17], v[16:17]
    v_pk_add_f32 v[28:29], v[28:29], v[20:21]
    v_pk_fma_f32 v[30:31], v[18:19], v[18:19], v[30:31]
    v_pk_add_f32 v[28:29], v[28:29], v[22:23]
    v_pk_fma_f32 v[30:31], v[20:21], v[20:21], v[30:31]
    v_add_f32 v28, v28, v29
    v_pk_fma_f32 v[30:31], v[22:23], v[22:23], v[30:31]
    v_add_f32 v30, v30, v31
    ds_read_b64_tr_b16 v[84:85], v7 offset:20480
    ds_read_b64_tr_b16 v[86:87], v7 offset:20992
    v_permlane32_swap_b32 v28, v30
    v_add_f32 v28, v28, v30
    ds_read_b64_tr_b16 v[88:89], v7 offset:24576
    ds_read_b64_tr_b16 v[90:91], v7 offset:25088
    v_add_f32_dpp v28, v28, v28 quad_perm:[1,0,3,2] row_mask:0xf bank_mask:0xf
    ds_read_b64_tr_b16 v[92:93], v7 offset:28672
    ds_read_b64_tr_b16 v[94:95], v7 offset:29184
    v_add_f32_dpp v28, v28, v28 quad_perm:[2,3,0,1] row_mask:0xf bank_mask:0xf
    ds_read_b64_tr_b16 v[96:97], v7 offset:32768
    ds_read_b64_tr_b16 v[98:99], v7 offset:33280
    v_add_f32_dpp v28, v28, v28 row_half_mirror row_mask:0xf bank_mask:0xf
    ds_read_b64_tr_b16 v[100:101], v7 offset:36864
    ds_read_b64_tr_b16 v[102:103], v7 offset:37376
    v_add_f32_dpp v28, v28, v28 row_mirror row_mask:0xf bank_mask:0xf
    ds_read_b64_tr_b16 v[104:105], v7 offset:40960
    ds_read_b64_tr_b16 v[106:107], v7 offset:41472
    v_add_f32_dpp v28, v28, v28 row_bcast:15 row_mask:0xa bank_mask:0xf
    v_mov_b32 v30, 0x3b000000
    v_readlane_b32 s30, v28, 31
    v_readlane_b32 s31, v28, 63
    v_mov_b32 v31, 0x3f800054
    v_mul_f32 v28, s30, v30
    v_mul_f32 v29, s31, v30
    v_fma_f32 v29, -v28, v28, v29
    v_max_f32 v29, 0, v29
    v_fmaak_f32 v30, v29, v31, 0x2edbe6ff
    v_rsq_f32 v30, v30
    ds_read_b64_tr_b16 v[108:109], v7 offset:45056
    ds_read_b64_tr_b16 v[110:111], v7 offset:45568
    v_mul_f32 v31, v28, v30
    v_pk_fma_f32 v[16:17], v[16:17], v[30:31], v[30:31] op_sel:[0,0,1] op_sel_hi:[1,0,1] neg_lo:[0,0,1] neg_hi:[0,0,1]
    v_pk_fma_f32 v[18:19], v[18:19], v[30:31], v[30:31] op_sel:[0,0,1] op_sel_hi:[1,0,1] neg_lo:[0,0,1] neg_hi:[0,0,1]
    v_pk_fma_f32 v[20:21], v[20:21], v[30:31], v[30:31] op_sel:[0,0,1] op_sel_hi:[1,0,1] neg_lo:[0,0,1] neg_hi:[0,0,1]
    v_pk_fma_f32 v[22:23], v[22:23], v[30:31], v[30:31] op_sel:[0,0,1] op_sel_hi:[1,0,1] neg_lo:[0,0,1] neg_hi:[0,0,1]
    v_cvt_pk_bf16_f32 v24, v16, v17
    v_cvt_pk_bf16_f32 v25, v18, v19
    v_cvt_pk_bf16_f32 v26, v20, v21
    v_cvt_pk_bf16_f32 v27, v22, v23
    v_lshlrev_b32_sdwa v32, 1, v24 dst_sel:DWORD dst_unused:UNUSED_PAD src0_sel:DWORD src1_sel:WORD_0
    v_lshlrev_b32_sdwa v33, 1, v24 dst_sel:DWORD dst_unused:UNUSED_PAD src0_sel:DWORD src1_sel:WORD_1
    v_lshlrev_b32_sdwa v34, 1, v25 dst_sel:DWORD dst_unused:UNUSED_PAD src0_sel:DWORD src1_sel:WORD_0
    v_lshlrev_b32_sdwa v35, 1, v25 dst_sel:DWORD dst_unused:UNUSED_PAD src0_sel:DWORD src1_sel:WORD_1
    v_lshlrev_b32_sdwa v36, 1, v26 dst_sel:DWORD dst_unused:UNUSED_PAD src0_sel:DWORD src1_sel:WORD_0
    v_lshlrev_b32_sdwa v37, 1, v26 dst_sel:DWORD dst_unused:UNUSED_PAD src0_sel:DWORD src1_sel:WORD_1
    v_lshlrev_b32_sdwa v38, 1, v27 dst_sel:DWORD dst_unused:UNUSED_PAD src0_sel:DWORD src1_sel:WORD_0
    v_lshlrev_b32_sdwa v39, 1, v27 dst_sel:DWORD dst_unused:UNUSED_PAD src0_sel:DWORD src1_sel:WORD_1
    ds_read_u16_d16_hi v50, v32 offset:37888
    ds_read_u16_d16_hi v51, v33 offset:37888
    ds_read_u16_d16_hi v52, v34 offset:37888
    ds_read_u16_d16_hi v53, v35 offset:37888
    ds_read_u16_d16_hi v54, v36 offset:37888
    ds_read_u16_d16_hi v55, v37 offset:37888
    ds_read_u16_d16_hi v56, v38 offset:37888
    ds_read_u16_d16_hi v57, v39 offset:37888
    v_min3_f32 v28, |v16|, |v17|, |v18|
    v_max3_f32 v29, |v16|, |v17|, |v18|
    v_min3_f32 v28, v28, |v19|, |v20|
    v_max3_f32 v29, v29, |v19|, |v20|
    v_min3_f32 v28, v28, |v21|, |v22|
    v_max3_f32 v29, v29, |v21|, |v22|
    v_min_f32 v28, v28, |v23|
    v_max_f32 v29, v29, |v23|
    v_cmp_nle_f32 vcc, 0x36000000, v28
    v_mov_b32 v30, 0x41f80000
    v_cmp_nle_f32 s[30:31], v29, v30
    s_or_b64 vcc, vcc, s[30:31]
    s_waitcnt lgkmcnt(0)
    s_cbranch_vccnz L_slow
L_slowret:
    v_pk_add_f32 v[8:9], v[8:9], v[50:51]
    v_pk_add_f32 v[10:11], v[10:11], v[52:53]
    v_pk_add_f32 v[12:13], v[12:13], v[54:55]
    v_pk_add_f32 v[14:15], v[14:15], v[56:57]
    v_cvt_pk_bf16_f32 v24, v8, v9
    v_cvt_pk_bf16_f32 v25, v10, v11
    v_cvt_pk_bf16_f32 v26, v12, v13
    v_cvt_pk_bf16_f32 v27, v14, v15
    ds_write_b128 v62, v[24:27]
    v_lshlrev_b32 v8, 16, v24
    v_and_b32 v9, 0xffff0000, v24
    v_lshlrev_b32 v10, 16, v25
    v_and_b32 v11, 0xffff0000, v25
    v_lshlrev_b32 v12, 16, v26
    v_and_b32 v13, 0xffff0000, v26
    v_lshlrev_b32 v14, 16, v27
    v_and_b32 v15, 0xffff0000, v27
    v_readfirstlane_b32 s30, v8
    ds_read_b64_tr_b16 v[112:113], v7 offset:49152
    ds_read_b64_tr_b16 v[114:115], v7 offset:49664
    v_pk_add_f32 v[16:17], v[8:9], s[30:31] op_sel_hi:[1,0] neg_lo:[0,1] neg_hi:[0,1]
    v_pk_add_f32 v[18:19], v[10:11], s[30:31] op_sel_hi:[1,0] neg_lo:[0,1] neg_hi:[0,1]
    v_pk_add_f32 v[20:21], v[12:13], s[30:31] op_sel_hi:[1,0] neg_lo:[0,1] neg_hi:[0,1]
    v_pk_add_f32 v[22:23], v[14:15], s[30:31] op_sel_hi:[1,0] neg_lo:[0,1] neg_hi:[0,1]
    v_pk_add_f32 v[28:29], v[16:17], v[18:19]
    v_pk_mul_f32 v[30:31], v[16:17], v[16:17]
    v_pk_add_f32 v[28:29], v[28:29], v[20:21]
    v_pk_fma_f32 v[30:31], v[18:19], v[18:19], v[30:31]
    v_pk_add_f32 v[28:29], v[28:29], v[22:23]
    v_pk_fma_f32 v[30:31], v[20:21], v[20:21], v[30:31]
    v_add_f32 v28, v28, v29
    v_pk_fma_f32 v[30:31], v[22:23], v[22:23], v[30:31]
    v_add_f32 v30, v30, v31
    ds_read_b64_tr_b16 v[116:117], v7 offset:53248
    ds_read_b64_tr_b16 v[118:119], v7 offset:53760
    v_permlane32_swap_b32 v28, v30
    v_add_f32 v28, v28, v30
    ds_read_b64_tr_b16 v[120:121], v7 offset:57344
    ds_read_b64_tr_b16 v[122:123], v7 offset:57856
    v_add_f32_dpp v28, v28, v28 quad_perm:[1,0,3,2] row_mask:0xf bank_mask:0xf
    ds_read_b64_tr_b16 v[124:125], v7 offset:61440
    ds_read_b64_tr_b16 v[126:127], v7 offset:61952
    v_add_f32_dpp v28, v28, v28 quad_perm:[2,3,0,1] row_mask:0xf bank_mask:0xf
    s_nop 1
    v_add_f32_dpp v28, v28, v28 row_half_mirror row_mask:0xf bank_mask:0xf
    s_nop 1
    v_add_f32_dpp v28, v28, v28 row_mirror row_mask:0xf bank_mask:0xf
    s_nop 1
    v_add_f32_dpp v28, v28, v28 row_bcast:15 row_mask:0xa bank_mask:0xf
    v_mov_b32 v30, 0x3b000000
    v_readlane_b32 s30, v28, 31
    v_readlane_b32 s31, v28, 63
    v_mov_b32 v31, 0x3f800000
    v_mul_f32 v28, s30, v30
    v_mul_f32 v29, s31, v30
    v_fma_f32 v29, -v28, v28, v29
    v_max_f32 v29, 0, v29
    v_fmaak_f32 v30, v29, v31, 0x3727c5ac
    v_rsq_f32 v30, v30
    s_nop 0
    v_mul_f32 v31, v28, v30
    v_pk_fma_f32 v[16:17], v[16:17], v[30:31], v[30:31] op_sel:[0,0,1] op_sel_hi:[1,0,1] neg_lo:[0,0,1] neg_hi:[0,0,1]
    v_pk_fma_f32 v[18:19], v[18:19], v[30:31], v[30:31] op_sel:[0,0,1] op_sel_hi:[1,0,1] neg_lo:[0,0,1] neg_hi:[0,0,1]
    v_pk_fma_f32 v[20:21], v[20:21], v[30:31], v[30:31] op_sel:[0,0,1] op_sel_hi:[1,0,1] neg_lo:[0,0,1] neg_hi:[0,0,1]
    v_pk_fma_f32 v[22:23], v[22:23], v[30:31], v[30:31] op_sel:[0,0,1] op_sel_hi:[1,0,1] neg_lo:[0,0,1] neg_hi:[0,0,1]
    v_cvt_pk_bf16_f32 v56, v16, v17
    v_cvt_pk_bf16_f32 v57, v18, v19
    v_cvt_pk_bf16_f32 v58, v20, v21
    v_cvt_pk_bf16_f32 v59, v22, v23
    ds_write_b128 v61, v[56:59]
    ds_read_b128 v[24:27], v6 offset:0
    ds_read_b128 v[28:31], v6 offset:128
    ds_read_b128 v[32:35], v6 offset:256
    ds_read_b128 v[36:39], v6 offset:384
    ds_read_b128 v[40:43], v6 offset:512
    ds_read_b128 v[44:47], v6 offset:640
    ds_read_b128 v[48:51], v6 offset:768
    ds_read_b128 v[52:55], v6 offset:896
    s_waitcnt lgkmcnt(7)
    v_mfma_f32_16x16x32_bf16 v[16:19], v[64:67], v[24:27], 0
    v_mfma_f32_16x16x32_bf16 v[20:23], v[68:71], v[24:27], 0
    s_waitcnt lgkmcnt(6)
    v_mfma_f32_16x16x32_bf16 v[16:19], v[72:75], v[28:31], v[16:19]
    v_mfma_f32_16x16x32_bf16 v[20:23], v[76:79], v[28:31], v[20:23]
    s_waitcnt lgkmcnt(5)
    v_mfma_f32_16x16x32_bf16 v[16:19], v[80:83], v[32:35], v[16:19]
    v_mfma_f32_16x16x32_bf16 v[20:23], v[84:87], v[32:35], v[20:23]
    s_waitcnt lgkmcnt(4)
    v_mfma_f32_16x16x32_bf16 v[16:19], v[88:91], v[36:39], v[16:19]
    v_mfma_f32_16x16x32_bf16 v[20:23], v[92:95], v[36:39], v[20:23]
    s_waitcnt lgkmcnt(3)
    v_mfma_f32_16x16x32_bf16 v[16:19], v[96:99], v[40:43], v[16:19]
    v_mfma_f32_16x16x32_bf16 v[20:23], v[100:103], v[40:43], v[20:23]
    s_waitcnt lgkmcnt(2)
    v_mfma_f32_16x16x32_bf16 v[16:19], v[104:107], v[44:47], v[16:19]
    v_mfma_f32_16x16x32_bf16 v[20:23], v[108:111], v[44:47], v[20:23]
    s_waitcnt lgkmcnt(1)
    v_mfma_f32_16x16x32_bf16 v[16:19], v[112:115], v[48:51], v[16:19]
    s_mov_b32 vcc_lo, 0x00010001
    s_mov_b32 vcc_hi, 0x00010001
    v_mfma_f32_16x16x32_bf16 v[20:23], v[116:119], v[48:51], v[20:23]
    s_waitcnt lgkmcnt(0)
    v_mfma_f32_16x16x32_bf16 v[16:19], v[120:123], v[52:55], v[16:19]
    v_mfma_f32_16x16x32_bf16 v[20:23], v[124:127], v[52:55], v[20:23]
    s_nop 7
    v_add_f32_dpp v16, v20, v16 row_shl:1 row_mask:0xf bank_mask:0xf
    v_add_f32_dpp v17, v21, v17 row_shl:1 row_mask:0xf bank_mask:0xf
    v_add_f32_dpp v18, v22, v18 row_shl:1 row_mask:0xf bank_mask:0xf
    v_add_f32_dpp v19, v23, v19 row_shl:1 row_mask:0xf bank_mask:0xf
    s_mov_b64 exec, vcc
    v_cvt_pk_bf16_f32 v16, v16, v17
    v_cvt_pk_bf16_f32 v17, v18, v19
    v_min_u32 v16, 0xfffffffe, v16
    v_min_u32 v17, 0xfffffffe, v17
    s_cmp_eq_u32 s58, 1
    s_cbranch_scc1 L_4
    buffer_store_dwordx2 v[16:17], v60, s[48:51], s92 offen sc1
    s_branch L_5
L_4:
    buffer_store_dwordx2 v[16:17], v60, s[48:51], s92 offen
L_5:
    s_mov_b64 exec, -1
    ds_read_b32 v12, v63
    s_mov_b32 s57, 1
    s_setprio 3
    v_mov_b32 v56, 0x3f803f80
    v_mov_b32 v57, 0x3f803f80
    v_mov_b32 v58, 0x3f803f80
    v_mov_b32 v59, 0x3f803f80
    v_lshrrev_b32 v54, 2, v3
    v_lshlrev_b32 v55, v54, 1
    v_lshl_add_u32 v54, v54, 6, v5
    v_bfe_i32 v50, v55, 0, 1
    v_bfe_i32 v51, v55, 1, 1
    v_bfe_i32 v52, v55, 2, 1
    v_bfe_i32 v53, v55, 3, 1
    v_mov_b32 v55, 0x3e0293ee
    s_sub_u32 s96, s3, 4
    s_mul_i32 s30, s96, 592
    s_add_u32 s30, s30, 139264
    v_and_b32 v120, 0, v0
    v_mul_u32_u24 v120, 2368, v120
    v_add_u32 v120, s30, v120
    v_lshl_add_u32 v121, v0, 3, s30
    v_lshlrev_b32 v122, 3, v0
    v_and_b32 v123, 63, v122
    s_lshl_b32 s30, s96, 8
    s_add_u32 s30, s30, 159744
    v_lshl_add_u32 v124, v0, 2, s30
    s_lshl_b32 s97, s57, 19
    s_lshl_b32 s31, s56, 14
    s_add_u32 s97, s97, s31
    s_lshl_b32 s31, s96, 9
    s_add_u32 s97, s97, s31
    s_add_u32 s97, s97, 262144
    s_lshl_b32 s31, s54, 11
    s_add_u32 s92, s97, s31
    s_lshl_b32 s99, s57, 13
    s_lshl_b32 s31, s56, 8
    s_add_u32 s99, s99, s31
    s_lshl_b32 s31, s96, 6
    s_add_u32 s99, s99, s31
    s_add_u32 s99, s99, 1310720
    s_lshl3_add_u32 s93, s54, s99
    s_add_u32 s98, s97, 4096
    s_add_u32 s94, s97, 8192
    s_add_u32 s95, s97, 12288
    s_waitcnt lgkmcnt(0)
    v_lshlrev_b32 v8, 16, v12
    v_and_b32 v9, 0xffff0000, v12
    s_branch L_B5
L_q1slow:
    s_mov_b32 s101, s61
    v_lshrrev_b32 v56, 1, v0
    v_lshlrev_b32 v56, 6, v56
    v_lshl_add_u32 v56, v0, 5, v56
    s_mov_b32 s61, 1507328
    buffer_load_dwordx4 v[48:51], v56, s[48:51], s61 offen sc1
    buffer_load_dwordx4 v[52:55], v56, s[48:51], s61 offen offset:16 sc1
    s_mov_b32 s59, 262144
L_fb:
    s_waitcnt vmcnt(0)
    v_xor_b32 v48, s100, v48
    v_xor_b32 v49, s101, v49
    v_xor_b32 v50, s100, v50
    v_xor_b32 v51, s101, v51
    v_xor_b32 v52, s100, v52
    v_xor_b32 v53, s101, v53
    v_xor_b32 v54, s100, v54
    v_xor_b32 v55, s101, v55
    v_or3_b32 v48, v48, v50, v52
    v_or_b32 v48, v48, v54
    v_lshrrev_b32 v50, 4, v48
    v_or3_b32 v50, v50, v49, v51
    v_or3_b32 v50, v50, v53, v55
    v_cmp_ne_u32 vcc, 0, v50
    s_sub_u32 s59, s59, 1
    s_cbranch_scc1 L_fbk
    s_cbranch_vccz L_fbk
    v_lshrrev_b32 v56, 1, v0
    v_lshlrev_b32 v56, 6, v56
    v_lshl_add_u32 v56, v0, 5, v56
    s_mov_b32 s61, 1507328
    buffer_load_dwordx4 v[48:51], v56, s[48:51], s61 offen sc1
    buffer_load_dwordx4 v[52:55], v56, s[48:51], s61 offen offset:16 sc1
    s_branch L_fb
L_fbk:
    v_bfe_u32 v50, v0, 1, 3
    v_cmp_eq_u32 vcc, s53, v50
    s_nop 1
    v_cndmask_b32 v48, 0, v48, vcc
    v_cmp_ne_u32 vcc, 0, v48
    s_cbranch_vccnz L_q1s2
    s_mov_b32 s59, 262144
    s_cmp_eq_u32 s57, 0
    s_mov_b32 s57, 1
    s_cbranch_scc0 L_q1s2
    s_mov_b32 s61, s101
    s_mov_b32 s101, s100
    s_branch L_fl
L_q1s2:
    s_mov_b32 s58, 0
    v_add_u32 v7, 160768, v1
    v_lshlrev_b32 v6, 16, v3
    v_lshl_add_u32 v6, v2, 4, v6
    s_lshl2_add_u32 s60, s53, s52
    s_lshl3_add_u32 s60, s60, s54
    s_lshl_b32 s60, s60, 8
    s_add_u32 s60, s60, 1519616
    ds_read_b128 v[40:43], v7 offset:0
    ds_read_b128 v[44:47], v7 offset:64
    ds_read_b128 v[48:51], v7 offset:128
    ds_read_b128 v[52:55], v7 offset:192
    s_waitcnt lgkmcnt(0)
    s_mov_b32 exec_lo, 0x000f000f
    s_mov_b32 exec_hi, 0x000f000f
    buffer_store_dwordx4 v[40:43], v6, s[48:51], s60 offen offset:0 sc1
    buffer_store_dwordx4 v[44:47], v6, s[48:51], s60 offen offset:64 sc1
    buffer_store_dwordx4 v[48:51], v6, s[48:51], s60 offen offset:128 sc1
    buffer_store_dwordx4 v[52:55], v6, s[48:51], s60 offen offset:192 sc1
    s_mov_b64 exec, -1
    s_lshl_b32 s30, s56, 13
    s_add_u32 s30, s30, 1519616
    s_add_u32 s31, s30, 4096
    s_mov_b32 s59, 262144
L_q1s3:
    buffer_load_dwordx4 v[16:19], v1, s[48:51], s30 offen offset:0 sc1
    buffer_load_dwordx4 v[20:23], v1, s[48:51], s30 offen offset:1024 sc1
    buffer_load_dwordx4 v[24:27], v1, s[48:51], s30 offen offset:2048 sc1
    buffer_load_dwordx4 v[28:31], v1, s[48:51], s30 offen offset:3072 sc1
    buffer_load_dwordx4 v[32:35], v1, s[48:51], s31 offen offset:0 sc1
    buffer_load_dwordx4 v[36:39], v1, s[48:51], s31 offen offset:1024 sc1
    buffer_load_dwordx4 v[40:43], v1, s[48:51], s31 offen offset:2048 sc1
    buffer_load_dwordx4 v[44:47], v1, s[48:51], s31 offen offset:3072 sc1
    s_waitcnt vmcnt(0)
    s_branch L_q1chk
L_slow:
    s_load_dwordx4 s[16:19], s[0:1], 48
    s_waitcnt lgkmcnt(0)
    v_mov_b32 v40, 0
    global_load_ushort v41, v40, s[22:23]
    v_lshlrev_b32 v40, 1, v0
    s_waitcnt vmcnt(0)
    v_lshlrev_b32 v41, 16, v41
    v_lshlrev_b32 v42, 16, v24
    v_bfe_u32 v43, v42, 16, 15
    v_subrev_u32 v43, 13824, v43
    v_mov_b32 v44, 3072
    v_cmp_le_u32 s[84:85], v44, v43
L_6:
    s_cmp_eq_u64 s[84:85], 0
    s_cbranch_scc1 L_7
    s_ff1_i32_b64 s86, s[84:85]
    s_bitset0_b64 s[84:85], s86
    v_readlane_b32 s87, v42, s86
    s_call_b64 s[88:89], L_eval
    s_mov_b32 m0, s86
    v_writelane_b32 v50, s87, m0
    s_branch L_6
L_7:
    v_and_b32 v42, 0xffff0000, v24
    v_bfe_u32 v43, v42, 16, 15
    v_subrev_u32 v43, 13824, v43
    v_mov_b32 v44, 3072
    v_cmp_le_u32 s[84:85], v44, v43
L_8:
    s_cmp_eq_u64 s[84:85], 0
    s_cbranch_scc1 L_9
    s_ff1_i32_b64 s86, s[84:85]
    s_bitset0_b64 s[84:85], s86
    v_readlane_b32 s87, v42, s86
    s_call_b64 s[88:89], L_eval
    s_mov_b32 m0, s86
    v_writelane_b32 v51, s87, m0
    s_branch L_8
L_9:
    v_lshlrev_b32 v42, 16, v25
    v_bfe_u32 v43, v42, 16, 15
    v_subrev_u32 v43, 13824, v43
    v_mov_b32 v44, 3072
    v_cmp_le_u32 s[84:85], v44, v43
L_10:
    s_cmp_eq_u64 s[84:85], 0
    s_cbranch_scc1 L_11
    s_ff1_i32_b64 s86, s[84:85]
    s_bitset0_b64 s[84:85], s86
    v_readlane_b32 s87, v42, s86
    s_call_b64 s[88:89], L_eval
    s_mov_b32 m0, s86
    v_writelane_b32 v52, s87, m0
    s_branch L_10
L_11:
    v_and_b32 v42, 0xffff0000, v25
    v_bfe_u32 v43, v42, 16, 15
    v_subrev_u32 v43, 13824, v43
    v_mov_b32 v44, 3072
    v_cmp_le_u32 s[84:85], v44, v43
L_12:
    s_cmp_eq_u64 s[84:85], 0
    s_cbranch_scc1 L_13
    s_ff1_i32_b64 s86, s[84:85]
    s_bitset0_b64 s[84:85], s86
    v_readlane_b32 s87, v42, s86
    s_call_b64 s[88:89], L_eval
    s_mov_b32 m0, s86
    v_writelane_b32 v53, s87, m0
    s_branch L_12
L_13:
    v_lshlrev_b32 v42, 16, v26
    v_bfe_u32 v43, v42, 16, 15
    v_subrev_u32 v43, 13824, v43
    v_mov_b32 v44, 3072
    v_cmp_le_u32 s[84:85], v44, v43
L_14:
    s_cmp_eq_u64 s[84:85], 0
    s_cbranch_scc1 L_15
    s_ff1_i32_b64 s86, s[84:85]
    s_bitset0_b64 s[84:85], s86
    v_readlane_b32 s87, v42, s86
    s_call_b64 s[88:89], L_eval
    s_mov_b32 m0, s86
    v_writelane_b32 v54, s87, m0
    s_branch L_14
L_15:
    v_and_b32 v42, 0xffff0000, v26
    v_bfe_u32 v43, v42, 16, 15
    v_subrev_u32 v43, 13824, v43
    v_mov_b32 v44, 3072
    v_cmp_le_u32 s[84:85], v44, v43
L_16:
    s_cmp_eq_u64 s[84:85], 0
    s_cbranch_scc1 L_17
    s_ff1_i32_b64 s86, s[84:85]
    s_bitset0_b64 s[84:85], s86
    v_readlane_b32 s87, v42, s86
    s_call_b64 s[88:89], L_eval
    s_mov_b32 m0, s86
    v_writelane_b32 v55, s87, m0
    s_branch L_16
L_17:
    v_lshlrev_b32 v42, 16, v27
    v_bfe_u32 v43, v42, 16, 15
    v_subrev_u32 v43, 13824, v43
    v_mov_b32 v44, 3072
    v_cmp_le_u32 s[84:85], v44, v43
L_18:
    s_cmp_eq_u64 s[84:85], 0
    s_cbranch_scc1 L_19
    s_ff1_i32_b64 s86, s[84:85]
    s_bitset0_b64 s[84:85], s86
    v_readlane_b32 s87, v42, s86
    s_call_b64 s[88:89], L_eval
    s_mov_b32 m0, s86
    v_writelane_b32 v56, s87, m0
    s_branch L_18
L_19:
    v_and_b32 v42, 0xffff0000, v27
    v_bfe_u32 v43, v42, 16, 15
    v_subrev_u32 v43, 13824, v43
    v_mov_b32 v44, 3072
    v_cmp_le_u32 s[84:85], v44, v43
L_20:
    s_cmp_eq_u64 s[84:85], 0
    s_cbranch_scc1 L_21
    s_ff1_i32_b64 s86, s[84:85]
    s_bitset0_b64 s[84:85], s86
    v_readlane_b32 s87, v42, s86
    s_call_b64 s[88:89], L_eval
    s_mov_b32 m0, s86
    v_writelane_b32 v57, s87, m0
    s_branch L_20
L_21:
    s_cmp_eq_u32 s57, 0
    s_cbranch_scc1 L_slowret
    s_branch L_slowret2
L_eval:
    v_mov_b32 v45, 0
    v_mov_b32 v46, v40
    s_mov_b32 s90, 28
L_ev1:
    global_load_ushort v47, v46, s[16:17]
    global_load_ushort v48, v46, s[18:19]
    global_load_ushort v49, v46, s[20:21]
    v_add_u32 v46, 128, v46
    s_waitcnt vmcnt(0)
    v_lshlrev_b32 v47, 16, v47
    v_lshlrev_b32 v48, 16, v48
    v_lshlrev_b32 v49, 16, v49
    v_fmac_f32 v48, s87, v47
    v_mul_f32 v47, v48, v48
    v_mul_f32 v47, 0xbdd2d3e8, v47
    v_add_f32 v47, 0xc0135761, v47
    v_mul_f32 v47, v47, v48
    v_exp_f32 v47, v47
    s_nop 0
    v_add_f32 v47, 1.0, v47
    v_rcp_f32 v47, v47
    s_nop 0
    v_mul_f32 v47, v47, v48
    v_fmac_f32 v45, v47, v49
    s_sub_u32 s90, s90, 1
    s_cmp_lg_u32 s90, 0
    s_cbranch_scc1 L_ev1
    v_mov_b32 v46, v45
    s_nop 1
    v_permlane32_swap_b32 v45, v46
    v_add_f32 v45, v45, v46
    s_nop 1
    v_add_f32_dpp v45, v45, v45 quad_perm:[1,0,3,2] row_mask:0xf bank_mask:0xf
    s_nop 1
    v_add_f32_dpp v45, v45, v45 quad_perm:[2,3,0,1] row_mask:0xf bank_mask:0xf
    s_nop 1
    v_add_f32_dpp v45, v45, v45 row_half_mirror row_mask:0xf bank_mask:0xf
    s_nop 1
    v_add_f32_dpp v45, v45, v45 row_mirror row_mask:0xf bank_mask:0xf
    s_nop 1
    v_add_f32_dpp v45, v45, v45 row_bcast:15 row_mask:0xa bank_mask:0xf
    s_nop 0
    v_readlane_b32 s87, v45, 31
    v_readlane_b32 s90, v45, 63
    s_nop 0
    v_add_f32 v45, s87, v41
    v_cvt_pk_bf16_f32 v45, v45, v45
    v_lshlrev_b32 v45, 16, v45
    s_nop 0
    v_readfirstlane_b32 s87, v45
    s_nop 4
    s_setpc_b64 s[88:89]
L_out:
    s_cmp_lg_u32 s3, 4
    s_cbranch_scc1 L_fin
    s_lshl_b32 s30, s52, 10
    v_add_u32 v60, s30, v1
    s_waitcnt lgkmcnt(0)
    v_readfirstlane_b32 s30, v8
    s_nop 1
    v_pk_add_f32 v[16:17], v[8:9], s[30:31] op_sel_hi:[1,0] neg_lo:[0,1] neg_hi:[0,1]
    v_pk_add_f32 v[18:19], v[10:11], s[30:31] op_sel_hi:[1,0] neg_lo:[0,1] neg_hi:[0,1]
    v_pk_add_f32 v[20:21], v[12:13], s[30:31] op_sel_hi:[1,0] neg_lo:[0,1] neg_hi:[0,1]
    v_pk_add_f32 v[22:23], v[14:15], s[30:31] op_sel_hi:[1,0] neg_lo:[0,1] neg_hi:[0,1]
    v_pk_add_f32 v[28:29], v[16:17], v[18:19]
    v_pk_mul_f32 v[30:31], v[16:17], v[16:17]
    v_pk_add_f32 v[28:29], v[28:29], v[20:21]
    v_pk_fma_f32 v[30:31], v[18:19], v[18:19], v[30:31]
    v_pk_add_f32 v[28:29], v[28:29], v[22:23]
    v_pk_fma_f32 v[30:31], v[20:21], v[20:21], v[30:31]
    v_add_f32 v28, v28, v29
    v_pk_fma_f32 v[30:31], v[22:23], v[22:23], v[30:31]
    v_add_f32 v30, v30, v31
    s_nop 1
    v_permlane32_swap_b32 v28, v30
    v_add_f32 v28, v28, v30
    s_nop 1
    v_add_f32_dpp v28, v28, v28 quad_perm:[1,0,3,2] row_mask:0xf bank_mask:0xf
    s_nop 1
    v_add_f32_dpp v28, v28, v28 quad_perm:[2,3,0,1] row_mask:0xf bank_mask:0xf
    s_nop 1
    v_add_f32_dpp v28, v28, v28 row_half_mirror row_mask:0xf bank_mask:0xf
    s_nop 1
    v_add_f32_dpp v28, v28, v28 row_mirror row_mask:0xf bank_mask:0xf
    s_nop 1
    v_add_f32_dpp v28, v28, v28 row_bcast:15 row_mask:0xa bank_mask:0xf
    v_mov_b32 v30, 0x3b000000
    v_readlane_b32 s30, v28, 31
    v_readlane_b32 s31, v28, 63
    v_mov_b32 v31, 0x3f800054
    v_mul_f32 v28, s30, v30
    v_mul_f32 v29, s31, v30
    v_fma_f32 v29, -v28, v28, v29
    v_max_f32 v29, 0, v29
    v_fmaak_f32 v30, v29, v31, 0x2edbe6ff
    v_rsq_f32 v30, v30
    s_nop 0
    v_mul_f32 v31, v28, v30
    v_pk_fma_f32 v[16:17], v[16:17], v[30:31], v[30:31] op_sel:[0,0,1] op_sel_hi:[1,0,1] neg_lo:[0,0,1] neg_hi:[0,0,1]
    v_pk_fma_f32 v[18:19], v[18:19], v[30:31], v[30:31] op_sel:[0,0,1] op_sel_hi:[1,0,1] neg_lo:[0,0,1] neg_hi:[0,0,1]
    v_pk_fma_f32 v[20:21], v[20:21], v[30:31], v[30:31] op_sel:[0,0,1] op_sel_hi:[1,0,1] neg_lo:[0,0,1] neg_hi:[0,0,1]
    v_pk_fma_f32 v[22:23], v[22:23], v[30:31], v[30:31] op_sel:[0,0,1] op_sel_hi:[1,0,1] neg_lo:[0,0,1] neg_hi:[0,0,1]
    v_cvt_pk_bf16_f32 v24, v16, v17
    v_cvt_pk_bf16_f32 v25, v18, v19
    v_cvt_pk_bf16_f32 v26, v20, v21
    v_cvt_pk_bf16_f32 v27, v22, v23
    v_lshlrev_b32_sdwa v32, 1, v24 dst_sel:DWORD dst_unused:UNUSED_PAD src0_sel:DWORD src1_sel:WORD_0
    v_lshlrev_b32_sdwa v33, 1, v24 dst_sel:DWORD dst_unused:UNUSED_PAD src0_sel:DWORD src1_sel:WORD_1
    v_lshlrev_b32_sdwa v34, 1, v25 dst_sel:DWORD dst_unused:UNUSED_PAD src0_sel:DWORD src1_sel:WORD_0
    v_lshlrev_b32_sdwa v35, 1, v25 dst_sel:DWORD dst_unused:UNUSED_PAD src0_sel:DWORD src1_sel:WORD_1
    v_lshlrev_b32_sdwa v36, 1, v26 dst_sel:DWORD dst_unused:UNUSED_PAD src0_sel:DWORD src1_sel:WORD_0
    v_lshlrev_b32_sdwa v37, 1, v26 dst_sel:DWORD dst_unused:UNUSED_PAD src0_sel:DWORD src1_sel:WORD_1
    v_lshlrev_b32_sdwa v38, 1, v27 dst_sel:DWORD dst_unused:UNUSED_PAD src0_sel:DWORD src1_sel:WORD_0
    v_lshlrev_b32_sdwa v39, 1, v27 dst_sel:DWORD dst_unused:UNUSED_PAD src0_sel:DWORD src1_sel:WORD_1
    ds_read_u16_d16_hi v50, v32 offset:37888
    ds_read_u16_d16_hi v51, v33 offset:37888
    ds_read_u16_d16_hi v52, v34 offset:37888
    ds_read_u16_d16_hi v53, v35 offset:37888
    ds_read_u16_d16_hi v54, v36 offset:37888
    ds_read_u16_d16_hi v55, v37 offset:37888
    ds_read_u16_d16_hi v56, v38 offset:37888
    ds_read_u16_d16_hi v57, v39 offset:37888
    v_min3_f32 v28, |v16|, |v17|, |v18|
    v_max3_f32 v29, |v16|, |v17|, |v18|
    v_min3_f32 v28, v28, |v19|, |v20|
    v_max3_f32 v29, v29, |v19|, |v20|
    v_min3_f32 v28, v28, |v21|, |v22|
    v_max3_f32 v29, v29, |v21|, |v22|
    v_min_f32 v28, v28, |v23|
    v_max_f32 v29, v29, |v23|
    v_cmp_nle_f32 vcc, 0x36000000, v28
    v_mov_b32 v30, 0x41f80000
    v_cmp_nle_f32 s[30:31], v29, v30
    s_or_b64 vcc, vcc, s[30:31]
    s_waitcnt lgkmcnt(0)
    s_cbranch_vccnz L_slow
L_slowret2:
    v_pk_add_f32 v[8:9], v[8:9], v[50:51]
    v_pk_add_f32 v[10:11], v[10:11], v[52:53]
    v_pk_add_f32 v[12:13], v[12:13], v[54:55]
    v_pk_add_f32 v[14:15], v[14:15], v[56:57]
    v_cvt_pk_bf16_f32 v24, v8, v9
    v_cvt_pk_bf16_f32 v25, v10, v11
    v_cvt_pk_bf16_f32 v26, v12, v13
    v_cvt_pk_bf16_f32 v27, v14, v15
    global_store_dwordx4 v60, v[24:27], s[24:25]
    s_cmp_lg_u32 s55, 0
    s_cbranch_scc1 L_fin
    v_mov_b32 v16, s100
    v_mov_b32 v17, s101
    s_mov_b32 s30, 1515520
    s_mov_b64 exec, 1
    buffer_store_dwordx2 v[16:17], v1, s[48:51], s30 offen
L_fin:
L_end:
    s_endpgm
.section .rodata,"a"
.p2align 6
.amdhsa_kernel interleave_layers__sliding_block_cached__mixer_token_mlp__decode_kernel
  .amdhsa_next_free_vgpr 256
  .amdhsa_next_free_sgpr 102
  .amdhsa_accum_offset 256
  .amdhsa_group_segment_fixed_size 0
  .amdhsa_kernarg_size 104
  .amdhsa_user_sgpr_count 2
  .amdhsa_user_sgpr_kernarg_segment_ptr 1
  .amdhsa_system_sgpr_workgroup_id_x 1
  .amdhsa_float_denorm_mode_32 3
.end_amdhsa_kernel
```
